```python
import torch

def _softmax(x, axis=-1):
    return torch.softmax(x, dim=axis)
def _gelu(x):
    return torch.nn.functional.gelu(x, approximate="tanh")
def _silu(x):
    return torch.nn.functional.silu(x)
def _sigmoid(x):
    return torch.sigmoid(x)
def _layernorm(x, axis=-1, eps=1e-5):
    m = x.mean(dim=axis, keepdim=True)
    v = x.var(dim=axis, keepdim=True, unbiased=False)
    return (x - m) / torch.sqrt(v + eps)
def _scatter_add(tgt, idx, src, axis=0):
    return tgt.clone().index_add_(axis, idx, src)
def _segment_sum(src, seg, n):
    out = torch.zeros((n,) + src.shape[1:], dtype=src.dtype)
    return out.index_add_(0, seg, src)
def _pad(x, pw):
    flat = tuple(v for pair in reversed(pw) for v in pair)
    return torch.nn.functional.pad(x, flat)

kernel_name = 'sequential_preLN__gqa_block_cached__geglu_ffn__decode'

def setup_inputs():

    _w = (lambda a: (lambda t: t.to(torch.bfloat16) if t.is_floating_point() else t)(torch.as_tensor(a)))
    def _A_setup():
        B, Sq, D = 1, 1, 448
        Hq, Hkv, Sk, Dh = 16, 8, 32768, 256
        assert Hq % Hkv == 0, (Hq, Hkv)
        return {
            "x": _w((lambda *s: torch.randn(*s, dtype=torch.bfloat16) * 0.05)(B, Sq, D)),
            "k_cache": _w((lambda *s: torch.randn(*s, dtype=torch.bfloat16) * 3.2)(B, Hkv, Sk, Dh)),
            "v_cache": _w((lambda *s: torch.randn(*s, dtype=torch.bfloat16) * 0.4)(B, Hkv, Sk, Dh)),
            "wq": _w((lambda *s: torch.randn(*s, dtype=torch.bfloat16) * 3.2)(D, Hq * Dh) * (D ** -0.5)),
            "wo": _w((lambda *s: torch.randn(*s, dtype=torch.bfloat16) * 0.4)(Hq * Dh, D) * ((Hq * Dh) ** -0.5)),
        }
    _A_in = _A_setup()

    def _B_setup():
        B, S, D, F = 1, 1, 448, 1792
        return {
            "x": _w((lambda *s: torch.randn(*s, dtype=torch.bfloat16) * 0.05)(B, S, D)),
            "w_gate": _w((lambda *s: torch.randn(*s, dtype=torch.bfloat16) * 0.05)(D, F)),
            "w_up": _w((lambda *s: torch.randn(*s, dtype=torch.bfloat16) * 0.05)(D, F)),
            "w_down": _w((lambda *s: torch.randn(*s, dtype=torch.bfloat16) * 0.05)(F, D)),
        }
    _B_in = _B_setup()

    return {
        "A_x": _A_in["x"],
        "A_k_cache": _A_in["k_cache"],
        "A_v_cache": _A_in["v_cache"],
        "A_wq": _A_in["wq"],
        "A_wo": _A_in["wo"],
        "B_x": _B_in["x"],
        "B_w_gate": _B_in["w_gate"],
        "B_w_up": _B_in["w_up"],
        "B_w_down": _B_in["w_down"],
    }

def reference(A_x, A_k_cache, A_v_cache, A_wq, A_wo, B_x, B_w_gate, B_w_up, B_w_down):
    def _A_ref(x, k_cache, v_cache, wq, wo):
        B, Sq, D = x.shape
        Hq, Dh = 16, 256
        Hkv = k_cache.shape[1]
        rep = Hq // Hkv
        q = (lambda x, *d: x.permute(*d))((x @ wq).reshape(B, Sq, Hq, Dh), 0, 2, 1, 3)
        k = (lambda x, n, axis: torch.repeat_interleave(x, n, dim=axis))(k_cache, rep, axis=1)
        v = (lambda x, n, axis: torch.repeat_interleave(x, n, dim=axis))(v_cache, rep, axis=1)
        scores = torch.einsum("bhqd,bhkd->bhqk", q, k) * (Dh ** -0.5)
        p = _softmax(scores, axis=-1)
        o = torch.einsum("bhqk,bhkd->bhqd", p, v)
        return (lambda x, *d: x.permute(*d))(o, 0, 2, 1, 3).reshape(B, Sq, Hq * Dh) @ wo

    def _B_ref(x, w_gate, w_up, w_down):
        return (_gelu(x @ w_gate) * (x @ w_up)) @ w_down

    x = A_x
    h = x + _A_ref(_layernorm(x, axis=-1), A_k_cache, A_v_cache, A_wq, A_wo)
    h2 = h + _B_ref(_layernorm(h, axis=-1), B_w_gate, B_w_up, B_w_down)
    return h2
```

```asm
; @launch grid=(256,1,1) block=(512,1,1) lds=106688
.amdgcn_target "amdgcn-amd-amdhsa--gfx950"
.text
.globl sequential_preLN__gqa_block_cached__geglu_ffn__decode_kernel
.p2align 8
.type sequential_preLN__gqa_block_cached__geglu_ffn__decode_kernel,@function
sequential_preLN__gqa_block_cached__geglu_ffn__decode_kernel:
    s_cmp_ge_u32 s2, 256
    s_cbranch_scc1 L_exit
    s_load_dwordx16 s[32:47], s[0:1], 0
    s_load_dwordx8 s[48:55], s[0:1], 64
    v_lshrrev_b32 v3, 6, v0
    v_and_b32 v0, 63, v0
    s_and_b32 s4, s2, 7
    v_readfirstlane_b32 s3, v3
    s_lshr_b32 s5, s2, 3
    v_bfe_u32 v1, v0, 2, 2
    v_lshlrev_b32 v1, 9, v1
    v_lshrrev_b32 v4, 4, v0
    v_lshl_add_u32 v1, v4, 6, v1
    v_and_b32 v5, 3, v0
    v_lshl_add_u32 v1, v5, 4, v1
    v_and_b32 v5, 15, v0
    v_lshlrev_b32 v2, 4, v5
    v_lshl_add_u32 v2, v4, 9, v2
    s_lshl_b32 s28, s4, 24
    s_lshl_b32 s30, s5, 19
    s_add_u32 s28, s28, s30
    s_lshl_b32 s30, s3, 16
    s_add_u32 s28, s28, s30
    s_cmp_lg_u32 s3, 0
    s_waitcnt lgkmcnt(0)
    s_mov_b32 s8, s34
    s_mov_b32 s9, s35
    s_mov_b32 s10, 0x8000000
    s_mov_b32 s11, 0x20000
    s_cbranch_scc1 L_pref
    s_mov_b32 s20, s32
    s_mov_b32 s21, s33
    s_mov_b32 s22, 0x380
    s_mov_b32 s23, 0x20000
    s_mov_b32 s24, s38
    s_mov_b32 s25, s39
    s_mov_b32 s26, 0x380000
    s_mov_b32 s27, 0x20000
    v_lshlrev_b32 v6, 4, v0
    v_lshrrev_b32 v7, 3, v0
    v_lshlrev_b32 v3, 13, v7
    v_and_b32 v5, 7, v0
    v_lshl_add_u32 v3, v5, 4, v3
    s_and_b32 s72, s5, 3
    s_lshr_b32 s73, s5, 2
    s_mul_i32 s74, s72, 917504
    s_lshl_b32 s30, s4, 10
    s_add_u32 s74, s74, s30
    s_lshl_b32 s30, s73, 7
    s_add_u32 s74, s74, s30
    buffer_load_dwordx4 v[16:19], v6, s[20:23], 0 offen
    s_add_u32 s30, s74, 0
    buffer_load_dwordx4 v[32:35], v3, s[24:27], s30 offen nt
    s_add_u32 s30, s74, 65536
    buffer_load_dwordx4 v[36:39], v3, s[24:27], s30 offen nt
    s_add_u32 s30, s74, 131072
    buffer_load_dwordx4 v[40:43], v3, s[24:27], s30 offen nt
    s_add_u32 s30, s74, 196608
    buffer_load_dwordx4 v[44:47], v3, s[24:27], s30 offen nt
    s_add_u32 s30, s74, 262144
    buffer_load_dwordx4 v[48:51], v3, s[24:27], s30 offen nt
    s_add_u32 s30, s74, 327680
    buffer_load_dwordx4 v[52:55], v3, s[24:27], s30 offen nt
    s_add_u32 s30, s74, 393216
    buffer_load_dwordx4 v[56:59], v3, s[24:27], s30 offen nt
    s_add_u32 s30, s74, 458752
    buffer_load_dwordx4 v[60:63], v3, s[24:27], s30 offen nt
    s_add_u32 s30, s74, 524288
    buffer_load_dwordx4 v[64:67], v3, s[24:27], s30 offen nt
    s_add_u32 s30, s74, 589824
    buffer_load_dwordx4 v[68:71], v3, s[24:27], s30 offen nt
    s_add_u32 s30, s74, 655360
    buffer_load_dwordx4 v[72:75], v3, s[24:27], s30 offen nt
    s_add_u32 s30, s74, 720896
    buffer_load_dwordx4 v[76:79], v3, s[24:27], s30 offen nt
    s_add_u32 s30, s74, 786432
    buffer_load_dwordx4 v[80:83], v3, s[24:27], s30 offen nt
    s_add_u32 s30, s74, 851968
    buffer_load_dwordx4 v[84:87], v3, s[24:27], s30 offen nt
    s_load_dword s6, s[54:55], 0
    s_add_u32 s29, s28, 0
    buffer_load_dwordx4 a[0:3], v1, s[8:11], s29 offen offset:0 nt
    buffer_load_dwordx4 a[4:7], v1, s[8:11], s29 offen offset:256 nt
    buffer_load_dwordx4 a[8:11], v1, s[8:11], s29 offen offset:2048 nt
    buffer_load_dwordx4 a[12:15], v1, s[8:11], s29 offen offset:2304 nt
    s_add_u32 s29, s28, 4096
    buffer_load_dwordx4 a[16:19], v1, s[8:11], s29 offen offset:0 nt
    buffer_load_dwordx4 a[20:23], v1, s[8:11], s29 offen offset:256 nt
    buffer_load_dwordx4 a[24:27], v1, s[8:11], s29 offen offset:2048 nt
    buffer_load_dwordx4 a[28:31], v1, s[8:11], s29 offen offset:2304 nt
    s_add_u32 s29, s28, 8192
    buffer_load_dwordx4 a[32:35], v1, s[8:11], s29 offen offset:0 nt
    buffer_load_dwordx4 a[36:39], v1, s[8:11], s29 offen offset:256 nt
    buffer_load_dwordx4 a[40:43], v1, s[8:11], s29 offen offset:2048 nt
    buffer_load_dwordx4 a[44:47], v1, s[8:11], s29 offen offset:2304 nt
    s_mov_b32 s58, 0x07060501
    s_mov_b32 s59, 0x07060502
    s_mov_b32 s60, 0x07060503
    s_mov_b32 s61, 0x0c04000c
    s_mov_b32 s62, 0x04020100
    s_mov_b32 s63, 0x3db8aa3b
    v_cmp_gt_u32 vcc, 56, v0
    v_mov_b32 v22, 0
    v_mov_b32 v23, 1.0
    v_cndmask_b32 v22, v22, v23, vcc
    s_waitcnt vmcnt(26)
    v_lshlrev_b32 v8, 16, v16
    v_and_b32 v9, 0xffff0000, v16
    v_lshlrev_b32 v10, 16, v17
    v_and_b32 v11, 0xffff0000, v17
    v_lshlrev_b32 v12, 16, v18
    v_and_b32 v13, 0xffff0000, v18
    v_lshlrev_b32 v14, 16, v19
    v_and_b32 v15, 0xffff0000, v19
    v_add_f32 v88, v8, v9
    v_add_f32 v89, v10, v11
    v_add_f32 v90, v12, v13
    v_add_f32 v91, v14, v15
    v_add_f32 v88, v88, v89
    v_add_f32 v90, v90, v91
    v_add_f32 v88, v88, v90
    s_nop 1
    v_add_f32_dpp v88, v88, v88 row_shr:1 row_mask:0xf bank_mask:0xf bound_ctrl:0
    s_nop 1
    v_add_f32_dpp v88, v88, v88 row_shr:2 row_mask:0xf bank_mask:0xf bound_ctrl:0
    s_nop 1
    v_add_f32_dpp v88, v88, v88 row_shr:4 row_mask:0xf bank_mask:0xf bound_ctrl:0
    s_nop 1
    v_add_f32_dpp v88, v88, v88 row_shr:8 row_mask:0xf bank_mask:0xf bound_ctrl:0
    s_nop 1
    v_add_f32_dpp v88, v88, v88 row_bcast:15 row_mask:0xa bank_mask:0xf
    s_nop 1
    v_add_f32_dpp v88, v88, v88 row_bcast:31 row_mask:0xc bank_mask:0xf
    s_nop 1
    v_readlane_b32 s30, v88, 63
    s_nop 1
    v_mov_b32 v91, s30
    v_mul_f32 v92, 0x3b124925, v91
    v_mov_b32 v93, 0x43e00000
    v_fma_f32 v91, -v92, v93, v91
    v_mov_b32 v93, 0x3b124925
    v_fma_f32 v92, v91, v93, v92
    v_sub_f32 v88, v8, v92
    v_mul_f32 v89, v88, v88
    v_sub_f32 v88, v9, v92
    v_fma_f32 v89, v88, v88, v89
    v_sub_f32 v88, v10, v92
    v_fma_f32 v89, v88, v88, v89
    v_sub_f32 v88, v11, v92
    v_fma_f32 v89, v88, v88, v89
    v_sub_f32 v88, v12, v92
    v_fma_f32 v89, v88, v88, v89
    v_sub_f32 v88, v13, v92
    v_fma_f32 v89, v88, v88, v89
    v_sub_f32 v88, v14, v92
    v_fma_f32 v89, v88, v88, v89
    v_sub_f32 v88, v15, v92
    v_fma_f32 v89, v88, v88, v89
    v_mul_f32 v89, v89, v22
    s_nop 1
    v_add_f32_dpp v89, v89, v89 row_shr:1 row_mask:0xf bank_mask:0xf bound_ctrl:0
    s_nop 1
    v_add_f32_dpp v89, v89, v89 row_shr:2 row_mask:0xf bank_mask:0xf bound_ctrl:0
    s_nop 1
    v_add_f32_dpp v89, v89, v89 row_shr:4 row_mask:0xf bank_mask:0xf bound_ctrl:0
    s_nop 1
    v_add_f32_dpp v89, v89, v89 row_shr:8 row_mask:0xf bank_mask:0xf bound_ctrl:0
    s_nop 1
    v_add_f32_dpp v89, v89, v89 row_bcast:15 row_mask:0xa bank_mask:0xf
    s_nop 1
    v_add_f32_dpp v89, v89, v89 row_bcast:31 row_mask:0xc bank_mask:0xf
    s_nop 1
    v_readlane_b32 s30, v89, 63
    s_nop 1
    v_mov_b32 v91, s30
    v_mul_f32 v90, 0x3b124925, v91
    v_mov_b32 v93, 0x43e00000
    v_fma_f32 v91, -v90, v93, v91
    v_mov_b32 v93, 0x3b124925
    v_fma_f32 v90, v91, v93, v90
    v_cvt_pk_bf16_f32 v88, v92, v92
    v_lshlrev_b32 v88, 16, v88
    v_cvt_pk_bf16_f32 v90, v90, v90
    v_lshlrev_b32 v90, 16, v90
    v_add_f32 v90, 0x3727c5ac, v90
    v_cvt_pk_bf16_f32 v90, v90, v90
    v_lshlrev_b32 v90, 16, v90
    v_sqrt_f32 v89, v90
    s_nop 0
    v_cvt_pk_bf16_f32 v89, v89, v89
    v_lshlrev_b32 v89, 16, v89
    v_rcp_f32 v90, v89
    s_nop 0
    v_sub_f32 v94, v8, v88
    v_cvt_pk_bf16_f32 v94, v94, v94
    v_lshlrev_b32 v94, 16, v94
    v_mul_f32 v95, v94, v90
    v_fma_f32 v94, -v95, v89, v94
    v_fma_f32 v95, v94, v90, v95
    v_cvt_pk_bf16_f32 v8, v95, v95
    v_lshlrev_b32 v8, 16, v8
    v_sub_f32 v94, v9, v88
    v_cvt_pk_bf16_f32 v94, v94, v94
    v_lshlrev_b32 v94, 16, v94
    v_mul_f32 v95, v94, v90
    v_fma_f32 v94, -v95, v89, v94
    v_fma_f32 v95, v94, v90, v95
    v_cvt_pk_bf16_f32 v9, v95, v95
    v_lshlrev_b32 v9, 16, v9
    v_sub_f32 v94, v10, v88
    v_cvt_pk_bf16_f32 v94, v94, v94
    v_lshlrev_b32 v94, 16, v94
    v_mul_f32 v95, v94, v90
    v_fma_f32 v94, -v95, v89, v94
    v_fma_f32 v95, v94, v90, v95
    v_cvt_pk_bf16_f32 v10, v95, v95
    v_lshlrev_b32 v10, 16, v10
    v_sub_f32 v94, v11, v88
    v_cvt_pk_bf16_f32 v94, v94, v94
    v_lshlrev_b32 v94, 16, v94
    v_mul_f32 v95, v94, v90
    v_fma_f32 v94, -v95, v89, v94
    v_fma_f32 v95, v94, v90, v95
    v_cvt_pk_bf16_f32 v11, v95, v95
    v_lshlrev_b32 v11, 16, v11
    v_sub_f32 v94, v12, v88
    v_cvt_pk_bf16_f32 v94, v94, v94
    v_lshlrev_b32 v94, 16, v94
    v_mul_f32 v95, v94, v90
    v_fma_f32 v94, -v95, v89, v94
    v_fma_f32 v95, v94, v90, v95
    v_cvt_pk_bf16_f32 v12, v95, v95
    v_lshlrev_b32 v12, 16, v12
    v_sub_f32 v94, v13, v88
    v_cvt_pk_bf16_f32 v94, v94, v94
    v_lshlrev_b32 v94, 16, v94
    v_mul_f32 v95, v94, v90
    v_fma_f32 v94, -v95, v89, v94
    v_fma_f32 v95, v94, v90, v95
    v_cvt_pk_bf16_f32 v13, v95, v95
    v_lshlrev_b32 v13, 16, v13
    v_sub_f32 v94, v14, v88
    v_cvt_pk_bf16_f32 v94, v94, v94
    v_lshlrev_b32 v94, 16, v94
    v_mul_f32 v95, v94, v90
    v_fma_f32 v94, -v95, v89, v94
    v_fma_f32 v95, v94, v90, v95
    v_cvt_pk_bf16_f32 v14, v95, v95
    v_lshlrev_b32 v14, 16, v14
    v_sub_f32 v94, v15, v88
    v_cvt_pk_bf16_f32 v94, v94, v94
    v_lshlrev_b32 v94, 16, v94
    v_mul_f32 v95, v94, v90
    v_fma_f32 v94, -v95, v89, v94
    v_fma_f32 v95, v94, v90, v95
    v_cvt_pk_bf16_f32 v15, v95, v95
    v_lshlrev_b32 v15, 16, v15
    s_mov_b32 s30, 0x07060302
    v_perm_b32 v4, v9, v8, s30
    v_perm_b32 v5, v11, v10, s30
    v_perm_b32 v6, v13, v12, s30
    v_perm_b32 v7, v15, v14, s30
    v_lshlrev_b32 v24, 4, v0
    v_add_u32 v24, 104576, v24
    ds_write_b128 v24, v[4:7]
    s_mul_i32 s30, s72, 224
    s_add_u32 s30, s30, 104576
    v_lshrrev_b32 v3, 3, v0
    v_lshlrev_b32 v3, 1, v3
    v_add_u32 v3, s30, v3
    s_waitcnt lgkmcnt(0)
    ds_read_u16 v16, v3 offset:0
    ds_read_u16 v17, v3 offset:16
    ds_read_u16 v18, v3 offset:32
    ds_read_u16 v19, v3 offset:48
    ds_read_u16 v20, v3 offset:64
    ds_read_u16 v21, v3 offset:80
    ds_read_u16 v22, v3 offset:96
    ds_read_u16 v23, v3 offset:112
    ds_read_u16 v24, v3 offset:128
    ds_read_u16 v25, v3 offset:144
    ds_read_u16 v26, v3 offset:160
    ds_read_u16 v27, v3 offset:176
    ds_read_u16 v28, v3 offset:192
    ds_read_u16 v29, v3 offset:208
    s_mul_i32 s6, s6, 0x9E3779B1
    s_add_u32 s6, s6, 0x7F4A7C15
    s_or_b32 s6, s6, 1
    s_sub_u32 s57, 0, s6
    s_waitcnt vmcnt(25) lgkmcnt(13)
    v_lshlrev_b32 v30, 16, v16
    v_dot2_f32_bf16 v8, v32, v16, 0
    v_dot2_f32_bf16 v9, v32, v30, 0
    v_dot2_f32_bf16 v10, v33, v16, 0
    v_dot2_f32_bf16 v11, v33, v30, 0
    v_dot2_f32_bf16 v12, v34, v16, 0
    v_dot2_f32_bf16 v13, v34, v30, 0
    v_dot2_f32_bf16 v14, v35, v16, 0
    v_dot2_f32_bf16 v15, v35, v30, 0
    s_waitcnt vmcnt(24) lgkmcnt(12)
    v_lshlrev_b32 v31, 16, v17
    v_dot2_f32_bf16 v8, v36, v17, v8
    v_dot2_f32_bf16 v9, v36, v31, v9
    v_dot2_f32_bf16 v10, v37, v17, v10
    v_dot2_f32_bf16 v11, v37, v31, v11
    v_dot2_f32_bf16 v12, v38, v17, v12
    v_dot2_f32_bf16 v13, v38, v31, v13
    v_dot2_f32_bf16 v14, v39, v17, v14
    v_dot2_f32_bf16 v15, v39, v31, v15
    s_waitcnt vmcnt(23) lgkmcnt(11)
    v_lshlrev_b32 v30, 16, v18
    v_dot2_f32_bf16 v8, v40, v18, v8
    v_dot2_f32_bf16 v9, v40, v30, v9
    v_dot2_f32_bf16 v10, v41, v18, v10
    v_dot2_f32_bf16 v11, v41, v30, v11
    v_dot2_f32_bf16 v12, v42, v18, v12
    v_dot2_f32_bf16 v13, v42, v30, v13
    v_dot2_f32_bf16 v14, v43, v18, v14
    v_dot2_f32_bf16 v15, v43, v30, v15
    s_waitcnt vmcnt(22) lgkmcnt(10)
    v_lshlrev_b32 v31, 16, v19
    v_dot2_f32_bf16 v8, v44, v19, v8
    v_dot2_f32_bf16 v9, v44, v31, v9
    v_dot2_f32_bf16 v10, v45, v19, v10
    v_dot2_f32_bf16 v11, v45, v31, v11
    v_dot2_f32_bf16 v12, v46, v19, v12
    v_dot2_f32_bf16 v13, v46, v31, v13
    v_dot2_f32_bf16 v14, v47, v19, v14
    v_dot2_f32_bf16 v15, v47, v31, v15
    s_waitcnt vmcnt(21) lgkmcnt(9)
    v_lshlrev_b32 v30, 16, v20
    v_dot2_f32_bf16 v8, v48, v20, v8
    v_dot2_f32_bf16 v9, v48, v30, v9
    v_dot2_f32_bf16 v10, v49, v20, v10
    v_dot2_f32_bf16 v11, v49, v30, v11
    v_dot2_f32_bf16 v12, v50, v20, v12
    v_dot2_f32_bf16 v13, v50, v30, v13
    v_dot2_f32_bf16 v14, v51, v20, v14
    v_dot2_f32_bf16 v15, v51, v30, v15
    s_waitcnt vmcnt(20) lgkmcnt(8)
    v_lshlrev_b32 v31, 16, v21
    v_dot2_f32_bf16 v8, v52, v21, v8
    v_dot2_f32_bf16 v9, v52, v31, v9
    v_dot2_f32_bf16 v10, v53, v21, v10
    v_dot2_f32_bf16 v11, v53, v31, v11
    v_dot2_f32_bf16 v12, v54, v21, v12
    v_dot2_f32_bf16 v13, v54, v31, v13
    v_dot2_f32_bf16 v14, v55, v21, v14
    v_dot2_f32_bf16 v15, v55, v31, v15
    s_waitcnt vmcnt(19) lgkmcnt(7)
    v_lshlrev_b32 v30, 16, v22
    v_dot2_f32_bf16 v8, v56, v22, v8
    v_dot2_f32_bf16 v9, v56, v30, v9
    v_dot2_f32_bf16 v10, v57, v22, v10
    v_dot2_f32_bf16 v11, v57, v30, v11
    v_dot2_f32_bf16 v12, v58, v22, v12
    v_dot2_f32_bf16 v13, v58, v30, v13
    v_dot2_f32_bf16 v14, v59, v22, v14
    v_dot2_f32_bf16 v15, v59, v30, v15
    s_waitcnt vmcnt(18) lgkmcnt(6)
    v_lshlrev_b32 v31, 16, v23
    v_dot2_f32_bf16 v8, v60, v23, v8
    v_dot2_f32_bf16 v9, v60, v31, v9
    v_dot2_f32_bf16 v10, v61, v23, v10
    v_dot2_f32_bf16 v11, v61, v31, v11
    v_dot2_f32_bf16 v12, v62, v23, v12
    v_dot2_f32_bf16 v13, v62, v31, v13
    v_dot2_f32_bf16 v14, v63, v23, v14
    v_dot2_f32_bf16 v15, v63, v31, v15
    s_waitcnt vmcnt(17) lgkmcnt(5)
    v_lshlrev_b32 v30, 16, v24
    v_dot2_f32_bf16 v8, v64, v24, v8
    v_dot2_f32_bf16 v9, v64, v30, v9
    v_dot2_f32_bf16 v10, v65, v24, v10
    v_dot2_f32_bf16 v11, v65, v30, v11
    v_dot2_f32_bf16 v12, v66, v24, v12
    v_dot2_f32_bf16 v13, v66, v30, v13
    v_dot2_f32_bf16 v14, v67, v24, v14
    v_dot2_f32_bf16 v15, v67, v30, v15
    s_waitcnt vmcnt(16) lgkmcnt(4)
    v_lshlrev_b32 v31, 16, v25
    v_dot2_f32_bf16 v8, v68, v25, v8
    v_dot2_f32_bf16 v9, v68, v31, v9
    v_dot2_f32_bf16 v10, v69, v25, v10
    v_dot2_f32_bf16 v11, v69, v31, v11
    v_dot2_f32_bf16 v12, v70, v25, v12
    v_dot2_f32_bf16 v13, v70, v31, v13
    v_dot2_f32_bf16 v14, v71, v25, v14
    v_dot2_f32_bf16 v15, v71, v31, v15
    s_waitcnt vmcnt(15) lgkmcnt(3)
    v_lshlrev_b32 v30, 16, v26
    v_dot2_f32_bf16 v8, v72, v26, v8
    v_dot2_f32_bf16 v9, v72, v30, v9
    v_dot2_f32_bf16 v10, v73, v26, v10
    v_dot2_f32_bf16 v11, v73, v30, v11
    v_dot2_f32_bf16 v12, v74, v26, v12
    v_dot2_f32_bf16 v13, v74, v30, v13
    v_dot2_f32_bf16 v14, v75, v26, v14
    v_dot2_f32_bf16 v15, v75, v30, v15
    s_waitcnt vmcnt(14) lgkmcnt(2)
    v_lshlrev_b32 v31, 16, v27
    v_dot2_f32_bf16 v8, v76, v27, v8
    v_dot2_f32_bf16 v9, v76, v31, v9
    v_dot2_f32_bf16 v10, v77, v27, v10
    v_dot2_f32_bf16 v11, v77, v31, v11
    v_dot2_f32_bf16 v12, v78, v27, v12
    v_dot2_f32_bf16 v13, v78, v31, v13
    v_dot2_f32_bf16 v14, v79, v27, v14
    v_dot2_f32_bf16 v15, v79, v31, v15
    s_waitcnt vmcnt(13) lgkmcnt(1)
    v_lshlrev_b32 v30, 16, v28
    v_dot2_f32_bf16 v8, v80, v28, v8
    v_dot2_f32_bf16 v9, v80, v30, v9
    v_dot2_f32_bf16 v10, v81, v28, v10
    v_dot2_f32_bf16 v11, v81, v30, v11
    v_dot2_f32_bf16 v12, v82, v28, v12
    v_dot2_f32_bf16 v13, v82, v30, v13
    v_dot2_f32_bf16 v14, v83, v28, v14
    v_dot2_f32_bf16 v15, v83, v30, v15
    s_waitcnt vmcnt(12) lgkmcnt(0)
    v_lshlrev_b32 v31, 16, v29
    v_dot2_f32_bf16 v8, v84, v29, v8
    v_dot2_f32_bf16 v9, v84, v31, v9
    v_dot2_f32_bf16 v10, v85, v29, v10
    v_dot2_f32_bf16 v11, v85, v31, v11
    v_dot2_f32_bf16 v12, v86, v29, v12
    v_dot2_f32_bf16 v13, v86, v31, v13
    v_dot2_f32_bf16 v14, v87, v29, v14
    v_dot2_f32_bf16 v15, v87, v31, v15
    s_nop 2
    v_add_f32_dpp v8, v8, v8 row_ror:8 row_mask:0xf bank_mask:0xf
    v_add_f32_dpp v9, v9, v9 row_ror:8 row_mask:0xf bank_mask:0xf
    v_add_f32_dpp v10, v10, v10 row_ror:8 row_mask:0xf bank_mask:0xf
    v_add_f32_dpp v11, v11, v11 row_ror:8 row_mask:0xf bank_mask:0xf
    v_add_f32_dpp v12, v12, v12 row_ror:8 row_mask:0xf bank_mask:0xf
    v_add_f32_dpp v13, v13, v13 row_ror:8 row_mask:0xf bank_mask:0xf
    v_add_f32_dpp v14, v14, v14 row_ror:8 row_mask:0xf bank_mask:0xf
    v_add_f32_dpp v15, v15, v15 row_ror:8 row_mask:0xf bank_mask:0xf
    v_mov_b32 v16, v8
    v_mov_b32 v17, v9
    v_mov_b32 v18, v10
    v_mov_b32 v19, v11
    v_mov_b32 v20, v12
    v_mov_b32 v21, v13
    v_mov_b32 v22, v14
    v_mov_b32 v23, v15
    v_permlane16_swap_b32 v8, v16
    v_permlane16_swap_b32 v9, v17
    v_permlane16_swap_b32 v10, v18
    v_permlane16_swap_b32 v11, v19
    v_permlane16_swap_b32 v12, v20
    v_permlane16_swap_b32 v13, v21
    v_permlane16_swap_b32 v14, v22
    v_permlane16_swap_b32 v15, v23
    v_add_f32 v8, v8, v16
    v_add_f32 v9, v9, v17
    v_add_f32 v10, v10, v18
    v_add_f32 v11, v11, v19
    v_add_f32 v12, v12, v20
    v_add_f32 v13, v13, v21
    v_add_f32 v14, v14, v22
    v_add_f32 v15, v15, v23
    v_mov_b32 v16, v8
    v_mov_b32 v17, v9
    v_mov_b32 v18, v10
    v_mov_b32 v19, v11
    v_mov_b32 v20, v12
    v_mov_b32 v21, v13
    v_mov_b32 v22, v14
    v_mov_b32 v23, v15
    v_permlane32_swap_b32 v8, v16
    v_permlane32_swap_b32 v9, v17
    v_permlane32_swap_b32 v10, v18
    v_permlane32_swap_b32 v11, v19
    v_permlane32_swap_b32 v12, v20
    v_permlane32_swap_b32 v13, v21
    v_permlane32_swap_b32 v14, v22
    v_permlane32_swap_b32 v15, v23
    v_add_f32 v8, v8, v16
    v_add_f32 v9, v9, v17
    v_add_f32 v10, v10, v18
    v_add_f32 v11, v11, v19
    v_add_f32 v12, v12, v20
    v_add_f32 v13, v13, v21
    v_add_f32 v14, v14, v22
    v_add_f32 v15, v15, v23
    v_add_u32 v8, 0x80, v8
    v_add_u32 v9, 0x80, v9
    v_add_u32 v10, 0x80, v10
    v_add_u32 v11, 0x80, v11
    v_add_u32 v12, 0x80, v12
    v_add_u32 v13, 0x80, v13
    v_add_u32 v14, 0x80, v14
    v_add_u32 v15, 0x80, v15
    s_mov_b32 s64, 0xff00ff00
    s_mov_b32 s65, 0xff00ff00
    v_cndmask_b32 v8, v8, v12, s[64:65]
    v_cndmask_b32 v9, v9, v13, s[64:65]
    v_cndmask_b32 v10, v10, v14, s[64:65]
    v_cndmask_b32 v11, v11, v15, s[64:65]
    v_perm_b32 v32, v8, v11, s58
    v_perm_b32 v33, v9, v11, s59
    v_perm_b32 v34, v10, v11, s60
    v_add3_u32 v35, v32, v33, v34
    v_sub_u32 v35, s6, v35
    s_lshl_b32 s30, s4, 13
    s_add_u32 s75, s30, 4096
    s_lshl_b32 s30, s72, 11
    s_lshl_b32 s31, s73, 8
    s_add_u32 s30, s30, s31
    s_add_u32 s30, s30, s75
    v_lshlrev_b32 v4, 4, v0
    v_add_u32 v4, s30, v4
    s_mov_b32 s16, s54
    s_mov_b32 s17, s55
    s_mov_b32 s18, 0x20000000
    s_mov_b32 s19, 0x20000
    s_mov_b64 exec, 0xffff
    buffer_store_dwordx4 v[32:35], v4, s[16:19], 0 offen sc1
    s_mov_b64 exec, -1
    s_mov_b32 s12, s36
    s_mov_b32 s13, s37
    s_mov_b32 s14, 0x8000000
    s_mov_b32 s15, 0x20000
    s_add_u32 s29, s28, 12288
    buffer_load_dwordx4 a[48:51], v1, s[8:11], s29 offen offset:0 nt
    buffer_load_dwordx4 a[52:55], v1, s[8:11], s29 offen offset:256 nt
    buffer_load_dwordx4 a[56:59], v1, s[8:11], s29 offen offset:2048 nt
    buffer_load_dwordx4 a[60:63], v1, s[8:11], s29 offen offset:2304 nt
    s_add_u32 s29, s28, 16384
    buffer_load_dwordx4 a[64:67], v1, s[8:11], s29 offen offset:0 nt
    buffer_load_dwordx4 a[68:71], v1, s[8:11], s29 offen offset:256 nt
    buffer_load_dwordx4 a[72:75], v1, s[8:11], s29 offen offset:2048 nt
    buffer_load_dwordx4 a[76:79], v1, s[8:11], s29 offen offset:2304 nt
    s_add_u32 s29, s28, 20480
    buffer_load_dwordx4 a[80:83], v1, s[8:11], s29 offen offset:0 nt
    buffer_load_dwordx4 a[84:87], v1, s[8:11], s29 offen offset:256 nt
    buffer_load_dwordx4 a[88:91], v1, s[8:11], s29 offen offset:2048 nt
    buffer_load_dwordx4 a[92:95], v1, s[8:11], s29 offen offset:2304 nt
    s_add_u32 s29, s28, 24576
    buffer_load_dwordx4 a[96:99], v1, s[8:11], s29 offen offset:0 nt
    buffer_load_dwordx4 a[100:103], v1, s[8:11], s29 offen offset:256 nt
    buffer_load_dwordx4 a[104:107], v1, s[8:11], s29 offen offset:2048 nt
    buffer_load_dwordx4 a[108:111], v1, s[8:11], s29 offen offset:2304 nt
    s_add_u32 s29, s28, 28672
    buffer_load_dwordx4 a[112:115], v1, s[8:11], s29 offen offset:0 nt
    buffer_load_dwordx4 a[116:119], v1, s[8:11], s29 offen offset:256 nt
    buffer_load_dwordx4 a[120:123], v1, s[8:11], s29 offen offset:2048 nt
    buffer_load_dwordx4 a[124:127], v1, s[8:11], s29 offen offset:2304 nt
    v_lshlrev_b32 v3, 4, v0
    v_add_u32 v4, s75, v3
    v_add_u32 v5, 4096, v4
    s_mov_b32 s7, 0
    buffer_load_dwordx4 v[40:43], v4, s[16:19], 0 offen offset:0 sc1
    buffer_load_dwordx4 v[44:47], v4, s[16:19], 0 offen offset:1024 sc1
    buffer_load_dwordx4 v[48:51], v4, s[16:19], 0 offen offset:2048 sc1
    buffer_load_dwordx4 v[52:55], v4, s[16:19], 0 offen offset:3072 sc1
    buffer_load_dwordx4 v[56:59], v5, s[16:19], 0 offen offset:0 sc1
    buffer_load_dwordx4 v[60:63], v5, s[16:19], 0 offen offset:1024 sc1
    buffer_load_dwordx4 v[64:67], v5, s[16:19], 0 offen offset:2048 sc1
    buffer_load_dwordx4 v[68:71], v5, s[16:19], 0 offen offset:3072 sc1
    s_branch Lpoll_1w
Lpoll_1:
    s_cmp_eq_u64 s[64:65], 0
    s_cbranch_scc1 Lsk_3
    s_mov_b64 exec, s[64:65]
    buffer_load_dwordx4 v[40:43], v4, s[16:19], 0 offen offset:0 sc1
Lsk_3:
    s_cmp_eq_u64 s[66:67], 0
    s_cbranch_scc1 Lsk_4
    s_mov_b64 exec, s[66:67]
    buffer_load_dwordx4 v[44:47], v4, s[16:19], 0 offen offset:1024 sc1
Lsk_4:
    s_cmp_eq_u64 s[68:69], 0
    s_cbranch_scc1 Lsk_5
    s_mov_b64 exec, s[68:69]
    buffer_load_dwordx4 v[48:51], v4, s[16:19], 0 offen offset:2048 sc1
Lsk_5:
    s_cmp_eq_u64 s[70:71], 0
    s_cbranch_scc1 Lsk_6
    s_mov_b64 exec, s[70:71]
    buffer_load_dwordx4 v[52:55], v4, s[16:19], 0 offen offset:3072 sc1
Lsk_6:
    s_cmp_eq_u64 s[72:73], 0
    s_cbranch_scc1 Lsk_7
    s_mov_b64 exec, s[72:73]
    buffer_load_dwordx4 v[56:59], v5, s[16:19], 0 offen offset:0 sc1
Lsk_7:
    s_cmp_eq_u64 s[74:75], 0
    s_cbranch_scc1 Lsk_8
    s_mov_b64 exec, s[74:75]
    buffer_load_dwordx4 v[60:63], v5, s[16:19], 0 offen offset:1024 sc1
Lsk_8:
    s_cmp_eq_u64 s[76:77], 0
    s_cbranch_scc1 Lsk_9
    s_mov_b64 exec, s[76:77]
    buffer_load_dwordx4 v[64:67], v5, s[16:19], 0 offen offset:2048 sc1
Lsk_9:
    s_cmp_eq_u64 s[78:79], 0
    s_cbranch_scc1 Lsk_10
    s_mov_b64 exec, s[78:79]
    buffer_load_dwordx4 v[68:71], v5, s[16:19], 0 offen offset:3072 sc1
Lsk_10:
    s_mov_b64 exec, -1
Lpoll_1w:
    s_waitcnt vmcnt(0)
    v_add3_u32 v72, v40, v41, v42
    v_add3_u32 v73, v44, v45, v46
    v_add3_u32 v74, v48, v49, v50
    v_add3_u32 v75, v52, v53, v54
    v_add3_u32 v76, v56, v57, v58
    v_add3_u32 v77, v60, v61, v62
    v_add3_u32 v78, v64, v65, v66
    v_add3_u32 v79, v68, v69, v70
    v_add3_u32 v72, v72, v43, s57
    v_add3_u32 v73, v73, v47, s57
    v_add3_u32 v74, v74, v51, s57
    v_add3_u32 v75, v75, v55, s57
    v_add3_u32 v76, v76, v59, s57
    v_add3_u32 v77, v77, v63, s57
    v_add3_u32 v78, v78, v67, s57
    v_add3_u32 v79, v79, v71, s57
    v_or3_b32 v95, v72, v73, v74
    v_or3_b32 v95, v95, v75, v76
    v_or3_b32 v95, v95, v77, v78
    v_or_b32 v95, v95, v79
    v_cmp_ne_u32 vcc, 0, v95
    s_add_u32 s7, s7, 1
    s_cbranch_vccz Lpolled_2
    v_cmp_ne_u32 s[64:65], 0, v72
    v_cmp_ne_u32 s[66:67], 0, v73
    v_cmp_ne_u32 s[68:69], 0, v74
    v_cmp_ne_u32 s[70:71], 0, v75
    v_cmp_ne_u32 s[72:73], 0, v76
    v_cmp_ne_u32 s[74:75], 0, v77
    v_cmp_ne_u32 s[76:77], 0, v78
    v_cmp_ne_u32 s[78:79], 0, v79
    s_cmp_gt_u32 s7, 0x100000
    s_cbranch_scc0 Lpoll_1
Lpolled_2:
    v_perm_b32 v43, v41, v40, s61
    v_perm_b32 v43, v42, v43, s62
    v_perm_b32 v47, v45, v44, s61
    v_perm_b32 v47, v46, v47, s62
    v_perm_b32 v51, v49, v48, s61
    v_perm_b32 v51, v50, v51, s62
    v_perm_b32 v55, v53, v52, s61
    v_perm_b32 v55, v54, v55, s62
    v_perm_b32 v59, v57, v56, s61
    v_perm_b32 v59, v58, v59, s62
    v_perm_b32 v63, v61, v60, s61
    v_perm_b32 v63, v62, v63, s62
    v_perm_b32 v67, v65, v64, s61
    v_perm_b32 v67, v66, v67, s62
    v_perm_b32 v71, v69, v68, s61
    v_perm_b32 v71, v70, v71, s62
    v_and_b32 v40, 0xffffff00, v40
    v_and_b32 v41, 0xffffff00, v41
    v_and_b32 v42, 0xffffff00, v42
    v_and_b32 v44, 0xffffff00, v44
    v_and_b32 v45, 0xffffff00, v45
    v_and_b32 v46, 0xffffff00, v46
    v_and_b32 v48, 0xffffff00, v48
    v_and_b32 v49, 0xffffff00, v49
    v_and_b32 v50, 0xffffff00, v50
    v_and_b32 v52, 0xffffff00, v52
    v_and_b32 v53, 0xffffff00, v53
    v_and_b32 v54, 0xffffff00, v54
    v_and_b32 v56, 0xffffff00, v56
    v_and_b32 v57, 0xffffff00, v57
    v_and_b32 v58, 0xffffff00, v58
    v_and_b32 v60, 0xffffff00, v60
    v_and_b32 v61, 0xffffff00, v61
    v_and_b32 v62, 0xffffff00, v62
    v_and_b32 v64, 0xffffff00, v64
    v_and_b32 v65, 0xffffff00, v65
    v_and_b32 v66, 0xffffff00, v66
    v_and_b32 v68, 0xffffff00, v68
    v_and_b32 v69, 0xffffff00, v69
    v_and_b32 v70, 0xffffff00, v70
    v_add_f32 v40, v40, v48
    v_add_f32 v56, v56, v64
    v_add_f32 v41, v41, v49
    v_add_f32 v57, v57, v65
    v_add_f32 v42, v42, v50
    v_add_f32 v58, v58, v66
    v_add_f32 v43, v43, v51
    v_add_f32 v59, v59, v67
    v_add_f32 v44, v44, v52
    v_add_f32 v60, v60, v68
    v_add_f32 v45, v45, v53
    v_add_f32 v61, v61, v69
    v_add_f32 v46, v46, v54
    v_add_f32 v62, v62, v70
    v_add_f32 v47, v47, v55
    v_add_f32 v63, v63, v71
    v_add_f32 v40, v40, v56
    v_add_f32 v41, v41, v57
    v_add_f32 v42, v42, v58
    v_add_f32 v43, v43, v59
    v_add_f32 v44, v44, v60
    v_add_f32 v45, v45, v61
    v_add_f32 v46, v46, v62
    v_add_f32 v47, v47, v63
    v_cvt_pk_bf16_f32 v48, v40, v41
    v_cvt_pk_bf16_f32 v49, v42, v43
    v_cvt_pk_bf16_f32 v50, v44, v45
    v_cvt_pk_bf16_f32 v51, v46, v47
    v_lshrrev_b32 v3, 4, v0
    v_lshlrev_b32 v3, 7, v3
    v_and_b32 v4, 7, v0
    v_lshl_add_u32 v3, v4, 4, v3
    v_bfe_u32 v4, v0, 3, 1
    v_lshl_add_u32 v3, v4, 3, v3
    v_add_u32 v3, 102528, v3
    ds_write_b64 v3, v[48:49]
    ds_write_b64 v3, v[50:51] offset:512
    s_branch L_qready
L_pref:
    s_add_u32 s29, s28, 0
    buffer_load_dwordx4 a[0:3], v1, s[8:11], s29 offen offset:0 nt
    buffer_load_dwordx4 a[4:7], v1, s[8:11], s29 offen offset:256 nt
    buffer_load_dwordx4 a[8:11], v1, s[8:11], s29 offen offset:2048 nt
    buffer_load_dwordx4 a[12:15], v1, s[8:11], s29 offen offset:2304 nt
    s_add_u32 s29, s28, 4096
    buffer_load_dwordx4 a[16:19], v1, s[8:11], s29 offen offset:0 nt
    buffer_load_dwordx4 a[20:23], v1, s[8:11], s29 offen offset:256 nt
    buffer_load_dwordx4 a[24:27], v1, s[8:11], s29 offen offset:2048 nt
    buffer_load_dwordx4 a[28:31], v1, s[8:11], s29 offen offset:2304 nt
    s_add_u32 s29, s28, 8192
    buffer_load_dwordx4 a[32:35], v1, s[8:11], s29 offen offset:0 nt
    buffer_load_dwordx4 a[36:39], v1, s[8:11], s29 offen offset:256 nt
    buffer_load_dwordx4 a[40:43], v1, s[8:11], s29 offen offset:2048 nt
    buffer_load_dwordx4 a[44:47], v1, s[8:11], s29 offen offset:2304 nt
    s_load_dword s6, s[54:55], 0
    s_mov_b32 s12, s36
    s_mov_b32 s13, s37
    s_mov_b32 s14, 0x8000000
    s_mov_b32 s15, 0x20000
    s_mov_b32 s16, s54
    s_mov_b32 s17, s55
    s_mov_b32 s18, 0x20000000
    s_mov_b32 s19, 0x20000
    s_mov_b32 s58, 0x07060501
    s_mov_b32 s59, 0x07060502
    s_mov_b32 s60, 0x07060503
    s_mov_b32 s61, 0x0c04000c
    s_mov_b32 s62, 0x04020100
    s_mov_b32 s63, 0x3db8aa3b
    s_waitcnt vmcnt(7)
    s_add_u32 s29, s28, 12288
    buffer_load_dwordx4 a[48:51], v1, s[8:11], s29 offen offset:0 nt
    s_waitcnt vmcnt(7)
    buffer_load_dwordx4 a[52:55], v1, s[8:11], s29 offen offset:256 nt
    s_waitcnt vmcnt(7)
    buffer_load_dwordx4 a[56:59], v1, s[8:11], s29 offen offset:2048 nt
    s_waitcnt vmcnt(7)
    buffer_load_dwordx4 a[60:63], v1, s[8:11], s29 offen offset:2304 nt
    s_waitcnt vmcnt(7)
    s_add_u32 s29, s28, 16384
    buffer_load_dwordx4 a[64:67], v1, s[8:11], s29 offen offset:0 nt
    s_waitcnt vmcnt(7)
    buffer_load_dwordx4 a[68:71], v1, s[8:11], s29 offen offset:256 nt
    s_waitcnt vmcnt(7)
    buffer_load_dwordx4 a[72:75], v1, s[8:11], s29 offen offset:2048 nt
    s_waitcnt vmcnt(7)
    buffer_load_dwordx4 a[76:79], v1, s[8:11], s29 offen offset:2304 nt
    s_waitcnt vmcnt(7)
    s_add_u32 s29, s28, 20480
    buffer_load_dwordx4 a[80:83], v1, s[8:11], s29 offen offset:0 nt
    s_waitcnt vmcnt(7)
    buffer_load_dwordx4 a[84:87], v1, s[8:11], s29 offen offset:256 nt
    s_waitcnt vmcnt(7)
    buffer_load_dwordx4 a[88:91], v1, s[8:11], s29 offen offset:2048 nt
    s_waitcnt vmcnt(7)
    buffer_load_dwordx4 a[92:95], v1, s[8:11], s29 offen offset:2304 nt
    s_waitcnt vmcnt(7)
    s_add_u32 s29, s28, 24576
    buffer_load_dwordx4 a[96:99], v1, s[8:11], s29 offen offset:0 nt
    s_waitcnt vmcnt(7)
    buffer_load_dwordx4 a[100:103], v1, s[8:11], s29 offen offset:256 nt
    s_waitcnt vmcnt(7)
    buffer_load_dwordx4 a[104:107], v1, s[8:11], s29 offen offset:2048 nt
    s_waitcnt vmcnt(7)
    buffer_load_dwordx4 a[108:111], v1, s[8:11], s29 offen offset:2304 nt
    s_waitcnt vmcnt(7)
    s_add_u32 s29, s28, 28672
    buffer_load_dwordx4 a[112:115], v1, s[8:11], s29 offen offset:0 nt
    s_waitcnt vmcnt(7)
    buffer_load_dwordx4 a[116:119], v1, s[8:11], s29 offen offset:256 nt
    s_waitcnt vmcnt(7)
    buffer_load_dwordx4 a[120:123], v1, s[8:11], s29 offen offset:2048 nt
    s_waitcnt vmcnt(7)
    buffer_load_dwordx4 a[124:127], v1, s[8:11], s29 offen offset:2304 nt
    s_waitcnt lgkmcnt(0)
    s_mul_i32 s6, s6, 0x9E3779B1
    s_add_u32 s6, s6, 0x7F4A7C15
    s_or_b32 s6, s6, 1
    s_sub_u32 s57, 0, s6
L_qready:
    v_and_b32 v5, 1, v0
    v_mov_b32 v6, 0xffff
    v_lshlrev_b32 v5, 4, v5
    v_lshlrev_b32 v6, v5, v6
    v_bfe_u32 v7, v0, 1, 2
    v_cmp_eq_u32 vcc, 0, v7
    s_nop 1
    v_cndmask_b32 v64, 0, v6, vcc
    v_cmp_eq_u32 vcc, 1, v7
    s_nop 1
    v_cndmask_b32 v65, 0, v6, vcc
    v_cmp_eq_u32 vcc, 2, v7
    s_nop 1
    v_cndmask_b32 v66, 0, v6, vcc
    v_cmp_eq_u32 vcc, 3, v7
    s_nop 1
    v_cndmask_b32 v67, 0, v6, vcc
    v_mov_b32 v84, 0xff800000
    v_bfe_u32 v3, v0, 3, 1
    v_lshlrev_b32 v3, 9, v3
    v_lshrrev_b32 v4, 4, v0
    v_lshl_add_u32 v3, v4, 6, v3
    v_and_b32 v5, 3, v0
    v_lshl_add_u32 v3, v5, 4, v3
    v_add_u32 v3, 102528, v3
    s_waitcnt lgkmcnt(0)
    s_barrier
    ds_read_b128 v[8:11], v3
    ds_read_b128 v[12:15], v3 offset:256
    v_lshrrev_b32 v4, 5, v0
    v_lshlrev_b32 v88, 10, v4
    v_and_b32 v5, 15, v0
    v_lshl_add_u32 v88, v5, 5, v88
    v_bfe_u32 v5, v0, 4, 1
    v_lshl_add_u32 v88, v5, 4, v88
    s_lshl_b32 s30, s3, 11
    s_add_u32 s30, s30, 86016
    v_add_u32 v88, s30, v88
    v_bfe_u32 v5, v0, 3, 1
    v_lshlrev_b32 v89, 6, v5
    s_lshl_b32 s30, s3, 3
    s_add_u32 s30, s30, 102400
    v_add_u32 v89, s30, v89
    v_lshlrev_b32 v3, 4, v0
    s_lshl_b32 s30, s3, 10
    s_add_u32 s30, s30, 86016
    v_add_u32 v90, s30, v3
    s_lshl_b32 s30, s3, 6
    s_add_u32 s30, s30, 102400
    v_mov_b32 v91, s30
    s_lshl_b32 s30, s4, 1
    s_add_u32 s30, s30, s3
    s_lshl_b32 s30, s30, 5
    s_add_u32 s30, s30, s5
    s_mul_i32 s30, s30, 1152
    s_add_u32 s30, s30, 131072
    v_add_u32 v92, s30, v3
    s_mov_b32 s68, 0
    s_mov_b32 s69, 0
    s_and_b32 s30, s4, 1
    s_cmp_lg_u32 s30, 0
    s_cbranch_scc1 Lrole_11
    s_lshr_b32 s30, s4, 1
    s_cmp_ge_u32 s30, 2
    s_cbranch_scc1 Lrole_11a
    s_cmp_ge_u32 s5, 28
    s_cbranch_scc1 Lrole_11
    s_mov_b32 s68, 2
    s_mul_i32 s69, s30, 28
    s_add_u32 s69, s69, s5
    s_branch Lrole_11
Lrole_11a:
    s_mov_b32 s68, 1
    s_sub_u32 s69, s30, 2
    s_lshl_b32 s69, s69, 5
    s_add_u32 s69, s69, s5
Lrole_11:
    s_waitcnt lgkmcnt(0)
    s_waitcnt vmcnt(30)
    v_mfma_f32_16x16x32_bf16 v[16:19], a[0:3], v[8:11], 0
    v_mfma_f32_16x16x32_bf16 v[16:19], a[4:7], v[12:15], v[16:19]
    s_add_u32 s29, s28, 32768
    buffer_load_dwordx4 a[0:3], v1, s[8:11], s29 offen offset:0 nt
    buffer_load_dwordx4 a[4:7], v1, s[8:11], s29 offen offset:256 nt
    s_waitcnt vmcnt(30)
    v_mfma_f32_16x16x32_bf16 v[20:23], a[8:11], v[8:11], 0
    v_mfma_f32_16x16x32_bf16 v[20:23], a[12:15], v[12:15], v[20:23]
    buffer_load_dwordx4 a[8:11], v1, s[8:11], s29 offen offset:2048 nt
    buffer_load_dwordx4 a[12:15], v1, s[8:11], s29 offen offset:2304 nt
    s_waitcnt vmcnt(30)
    v_mfma_f32_16x16x32_bf16 v[24:27], a[16:19], v[8:11], 0
    v_mfma_f32_16x16x32_bf16 v[24:27], a[20:23], v[12:15], v[24:27]
    s_add_u32 s29, s28, 36864
    buffer_load_dwordx4 a[16:19], v1, s[8:11], s29 offen offset:0 nt
    buffer_load_dwordx4 a[20:23], v1, s[8:11], s29 offen offset:256 nt
    v_mov_b32_dpp v32, v16 quad_perm:[0,0,0,0] row_mask:0xf bank_mask:0xf
    v_add_f32_dpp v32, v17, v32 quad_perm:[1,1,1,1] row_mask:0xf bank_mask:0xf
    v_add_f32_dpp v32, v18, v32 quad_perm:[2,2,2,2] row_mask:0xf bank_mask:0xf
    v_add_f32_dpp v32, v19, v32 quad_perm:[3,3,3,3] row_mask:0xf bank_mask:0xf
    v_max_f32 v84, v84, v32
    s_waitcnt vmcnt(30)
    v_mfma_f32_16x16x32_bf16 v[28:31], a[24:27], v[8:11], 0
    v_mfma_f32_16x16x32_bf16 v[28:31], a[28:31], v[12:15], v[28:31]
    buffer_load_dwordx4 a[24:27], v1, s[8:11], s29 offen offset:2048 nt
    buffer_load_dwordx4 a[28:31], v1, s[8:11], s29 offen offset:2304 nt
    v_mov_b32_dpp v33, v20 quad_perm:[0,0,0,0] row_mask:0xf bank_mask:0xf
    v_add_f32_dpp v33, v21, v33 quad_perm:[1,1,1,1] row_mask:0xf bank_mask:0xf
    v_add_f32_dpp v33, v22, v33 quad_perm:[2,2,2,2] row_mask:0xf bank_mask:0xf
    v_add_f32_dpp v33, v23, v33 quad_perm:[3,3,3,3] row_mask:0xf bank_mask:0xf
    v_max_f32 v84, v84, v33
    s_waitcnt vmcnt(30)
    v_mfma_f32_16x16x32_bf16 v[16:19], a[32:35], v[8:11], 0
    v_mfma_f32_16x16x32_bf16 v[16:19], a[36:39], v[12:15], v[16:19]
    s_add_u32 s29, s28, 40960
    buffer_load_dwordx4 a[32:35], v1, s[8:11], s29 offen offset:0 nt
    buffer_load_dwordx4 a[36:39], v1, s[8:11], s29 offen offset:256 nt
    v_mov_b32_dpp v34, v24 quad_perm:[0,0,0,0] row_mask:0xf bank_mask:0xf
    v_add_f32_dpp v34, v25, v34 quad_perm:[1,1,1,1] row_mask:0xf bank_mask:0xf
    v_add_f32_dpp v34, v26, v34 quad_perm:[2,2,2,2] row_mask:0xf bank_mask:0xf
    v_add_f32_dpp v34, v27, v34 quad_perm:[3,3,3,3] row_mask:0xf bank_mask:0xf
    v_max_f32 v84, v84, v34
    s_waitcnt vmcnt(30)
    v_mfma_f32_16x16x32_bf16 v[20:23], a[40:43], v[8:11], 0
    v_mfma_f32_16x16x32_bf16 v[20:23], a[44:47], v[12:15], v[20:23]
    buffer_load_dwordx4 a[40:43], v1, s[8:11], s29 offen offset:2048 nt
    buffer_load_dwordx4 a[44:47], v1, s[8:11], s29 offen offset:2304 nt
    v_mov_b32_dpp v35, v28 quad_perm:[0,0,0,0] row_mask:0xf bank_mask:0xf
    v_add_f32_dpp v35, v29, v35 quad_perm:[1,1,1,1] row_mask:0xf bank_mask:0xf
    v_add_f32_dpp v35, v30, v35 quad_perm:[2,2,2,2] row_mask:0xf bank_mask:0xf
    v_add_f32_dpp v35, v31, v35 quad_perm:[3,3,3,3] row_mask:0xf bank_mask:0xf
    v_max_f32 v84, v84, v35
    s_waitcnt vmcnt(30)
    v_mfma_f32_16x16x32_bf16 v[24:27], a[48:51], v[8:11], 0
    v_mfma_f32_16x16x32_bf16 v[24:27], a[52:55], v[12:15], v[24:27]
    s_add_u32 s29, s28, 45056
    buffer_load_dwordx4 a[48:51], v1, s[8:11], s29 offen offset:0 nt
    buffer_load_dwordx4 a[52:55], v1, s[8:11], s29 offen offset:256 nt
    v_mov_b32_dpp v36, v16 quad_perm:[0,0,0,0] row_mask:0xf bank_mask:0xf
    v_add_f32_dpp v36, v17, v36 quad_perm:[1,1,1,1] row_mask:0xf bank_mask:0xf
    v_add_f32_dpp v36, v18, v36 quad_perm:[2,2,2,2] row_mask:0xf bank_mask:0xf
    v_add_f32_dpp v36, v19, v36 quad_perm:[3,3,3,3] row_mask:0xf bank_mask:0xf
    v_max_f32 v84, v84, v36
    s_waitcnt vmcnt(30)
    v_mfma_f32_16x16x32_bf16 v[28:31], a[56:59], v[8:11], 0
    v_mfma_f32_16x16x32_bf16 v[28:31], a[60:63], v[12:15], v[28:31]
    buffer_load_dwordx4 a[56:59], v1, s[8:11], s29 offen offset:2048 nt
    buffer_load_dwordx4 a[60:63], v1, s[8:11], s29 offen offset:2304 nt
    v_mov_b32_dpp v37, v20 quad_perm:[0,0,0,0] row_mask:0xf bank_mask:0xf
    v_add_f32_dpp v37, v21, v37 quad_perm:[1,1,1,1] row_mask:0xf bank_mask:0xf
    v_add_f32_dpp v37, v22, v37 quad_perm:[2,2,2,2] row_mask:0xf bank_mask:0xf
    v_add_f32_dpp v37, v23, v37 quad_perm:[3,3,3,3] row_mask:0xf bank_mask:0xf
    v_max_f32 v84, v84, v37
    s_waitcnt vmcnt(30)
    v_mfma_f32_16x16x32_bf16 v[16:19], a[64:67], v[8:11], 0
    v_mfma_f32_16x16x32_bf16 v[16:19], a[68:71], v[12:15], v[16:19]
    s_add_u32 s29, s28, 49152
    buffer_load_dwordx4 a[64:67], v1, s[8:11], s29 offen offset:0 nt
    buffer_load_dwordx4 a[68:71], v1, s[8:11], s29 offen offset:256 nt
    v_mov_b32_dpp v38, v24 quad_perm:[0,0,0,0] row_mask:0xf bank_mask:0xf
    v_add_f32_dpp v38, v25, v38 quad_perm:[1,1,1,1] row_mask:0xf bank_mask:0xf
    v_add_f32_dpp v38, v26, v38 quad_perm:[2,2,2,2] row_mask:0xf bank_mask:0xf
    v_add_f32_dpp v38, v27, v38 quad_perm:[3,3,3,3] row_mask:0xf bank_mask:0xf
    v_max_f32 v84, v84, v38
    s_waitcnt vmcnt(30)
    v_mfma_f32_16x16x32_bf16 v[20:23], a[72:75], v[8:11], 0
    v_mfma_f32_16x16x32_bf16 v[20:23], a[76:79], v[12:15], v[20:23]
    buffer_load_dwordx4 a[72:75], v1, s[8:11], s29 offen offset:2048 nt
    buffer_load_dwordx4 a[76:79], v1, s[8:11], s29 offen offset:2304 nt
    v_mov_b32_dpp v39, v28 quad_perm:[0,0,0,0] row_mask:0xf bank_mask:0xf
    v_add_f32_dpp v39, v29, v39 quad_perm:[1,1,1,1] row_mask:0xf bank_mask:0xf
    v_add_f32_dpp v39, v30, v39 quad_perm:[2,2,2,2] row_mask:0xf bank_mask:0xf
    v_add_f32_dpp v39, v31, v39 quad_perm:[3,3,3,3] row_mask:0xf bank_mask:0xf
    v_max_f32 v84, v84, v39
    s_waitcnt vmcnt(30)
    v_mfma_f32_16x16x32_bf16 v[24:27], a[80:83], v[8:11], 0
    v_mfma_f32_16x16x32_bf16 v[24:27], a[84:87], v[12:15], v[24:27]
    s_add_u32 s29, s28, 53248
    buffer_load_dwordx4 a[80:83], v1, s[8:11], s29 offen offset:0 nt
    buffer_load_dwordx4 a[84:87], v1, s[8:11], s29 offen offset:256 nt
    v_mov_b32_dpp v40, v16 quad_perm:[0,0,0,0] row_mask:0xf bank_mask:0xf
    v_add_f32_dpp v40, v17, v40 quad_perm:[1,1,1,1] row_mask:0xf bank_mask:0xf
    v_add_f32_dpp v40, v18, v40 quad_perm:[2,2,2,2] row_mask:0xf bank_mask:0xf
    v_add_f32_dpp v40, v19, v40 quad_perm:[3,3,3,3] row_mask:0xf bank_mask:0xf
    v_max_f32 v84, v84, v40
    s_waitcnt vmcnt(30)
    v_mfma_f32_16x16x32_bf16 v[28:31], a[88:91], v[8:11], 0
    v_mfma_f32_16x16x32_bf16 v[28:31], a[92:95], v[12:15], v[28:31]
    buffer_load_dwordx4 a[88:91], v1, s[8:11], s29 offen offset:2048 nt
    buffer_load_dwordx4 a[92:95], v1, s[8:11], s29 offen offset:2304 nt
    v_mov_b32_dpp v41, v20 quad_perm:[0,0,0,0] row_mask:0xf bank_mask:0xf
    v_add_f32_dpp v41, v21, v41 quad_perm:[1,1,1,1] row_mask:0xf bank_mask:0xf
    v_add_f32_dpp v41, v22, v41 quad_perm:[2,2,2,2] row_mask:0xf bank_mask:0xf
    v_add_f32_dpp v41, v23, v41 quad_perm:[3,3,3,3] row_mask:0xf bank_mask:0xf
    v_max_f32 v84, v84, v41
    s_waitcnt vmcnt(30)
    v_mfma_f32_16x16x32_bf16 v[16:19], a[96:99], v[8:11], 0
    v_mfma_f32_16x16x32_bf16 v[16:19], a[100:103], v[12:15], v[16:19]
    s_add_u32 s29, s28, 57344
    buffer_load_dwordx4 a[96:99], v1, s[8:11], s29 offen offset:0 nt
    buffer_load_dwordx4 a[100:103], v1, s[8:11], s29 offen offset:256 nt
    v_mov_b32_dpp v42, v24 quad_perm:[0,0,0,0] row_mask:0xf bank_mask:0xf
    v_add_f32_dpp v42, v25, v42 quad_perm:[1,1,1,1] row_mask:0xf bank_mask:0xf
    v_add_f32_dpp v42, v26, v42 quad_perm:[2,2,2,2] row_mask:0xf bank_mask:0xf
    v_add_f32_dpp v42, v27, v42 quad_perm:[3,3,3,3] row_mask:0xf bank_mask:0xf
    v_max_f32 v84, v84, v42
    s_waitcnt vmcnt(30)
    v_mfma_f32_16x16x32_bf16 v[20:23], a[104:107], v[8:11], 0
    v_mfma_f32_16x16x32_bf16 v[20:23], a[108:111], v[12:15], v[20:23]
    buffer_load_dwordx4 a[104:107], v1, s[8:11], s29 offen offset:2048 nt
    buffer_load_dwordx4 a[108:111], v1, s[8:11], s29 offen offset:2304 nt
    v_mov_b32_dpp v43, v28 quad_perm:[0,0,0,0] row_mask:0xf bank_mask:0xf
    v_add_f32_dpp v43, v29, v43 quad_perm:[1,1,1,1] row_mask:0xf bank_mask:0xf
    v_add_f32_dpp v43, v30, v43 quad_perm:[2,2,2,2] row_mask:0xf bank_mask:0xf
    v_add_f32_dpp v43, v31, v43 quad_perm:[3,3,3,3] row_mask:0xf bank_mask:0xf
    v_max_f32 v84, v84, v43
    s_waitcnt vmcnt(30)
    v_mfma_f32_16x16x32_bf16 v[24:27], a[112:115], v[8:11], 0
    v_mfma_f32_16x16x32_bf16 v[24:27], a[116:119], v[12:15], v[24:27]
    s_add_u32 s29, s28, 61440
    buffer_load_dwordx4 a[112:115], v1, s[8:11], s29 offen offset:0 nt
    buffer_load_dwordx4 a[116:119], v1, s[8:11], s29 offen offset:256 nt
    v_mov_b32_dpp v44, v16 quad_perm:[0,0,0,0] row_mask:0xf bank_mask:0xf
    v_add_f32_dpp v44, v17, v44 quad_perm:[1,1,1,1] row_mask:0xf bank_mask:0xf
    v_add_f32_dpp v44, v18, v44 quad_perm:[2,2,2,2] row_mask:0xf bank_mask:0xf
    v_add_f32_dpp v44, v19, v44 quad_perm:[3,3,3,3] row_mask:0xf bank_mask:0xf
    v_max_f32 v84, v84, v44
    s_waitcnt vmcnt(30)
    v_mfma_f32_16x16x32_bf16 v[28:31], a[120:123], v[8:11], 0
    v_mfma_f32_16x16x32_bf16 v[28:31], a[124:127], v[12:15], v[28:31]
    buffer_load_dwordx4 a[120:123], v1, s[8:11], s29 offen offset:2048 nt
    buffer_load_dwordx4 a[124:127], v1, s[8:11], s29 offen offset:2304 nt
    v_mov_b32_dpp v45, v20 quad_perm:[0,0,0,0] row_mask:0xf bank_mask:0xf
    v_add_f32_dpp v45, v21, v45 quad_perm:[1,1,1,1] row_mask:0xf bank_mask:0xf
    v_add_f32_dpp v45, v22, v45 quad_perm:[2,2,2,2] row_mask:0xf bank_mask:0xf
    v_add_f32_dpp v45, v23, v45 quad_perm:[3,3,3,3] row_mask:0xf bank_mask:0xf
    v_max_f32 v84, v84, v45
    s_waitcnt vmcnt(30)
    v_mfma_f32_16x16x32_bf16 v[16:19], a[0:3], v[8:11], 0
    v_mfma_f32_16x16x32_bf16 v[16:19], a[4:7], v[12:15], v[16:19]
    s_add_u32 s29, s28, 0
    buffer_load_dwordx4 a[0:3], v2, s[12:15], s29 offen offset:0 nt
    buffer_load_dwordx4 a[4:7], v2, s[12:15], s29 offen offset:256 nt
    v_mov_b32_dpp v46, v24 quad_perm:[0,0,0,0] row_mask:0xf bank_mask:0xf
    v_add_f32_dpp v46, v25, v46 quad_perm:[1,1,1,1] row_mask:0xf bank_mask:0xf
    v_add_f32_dpp v46, v26, v46 quad_perm:[2,2,2,2] row_mask:0xf bank_mask:0xf
    v_add_f32_dpp v46, v27, v46 quad_perm:[3,3,3,3] row_mask:0xf bank_mask:0xf
    v_max_f32 v84, v84, v46
    s_waitcnt vmcnt(30)
    v_mfma_f32_16x16x32_bf16 v[20:23], a[8:11], v[8:11], 0
    v_mfma_f32_16x16x32_bf16 v[20:23], a[12:15], v[12:15], v[20:23]
    buffer_load_dwordx4 a[8:11], v2, s[12:15], s29 offen offset:2048 nt
    buffer_load_dwordx4 a[12:15], v2, s[12:15], s29 offen offset:2304 nt
    v_mov_b32_dpp v47, v28 quad_perm:[0,0,0,0] row_mask:0xf bank_mask:0xf
    v_add_f32_dpp v47, v29, v47 quad_perm:[1,1,1,1] row_mask:0xf bank_mask:0xf
    v_add_f32_dpp v47, v30, v47 quad_perm:[2,2,2,2] row_mask:0xf bank_mask:0xf
    v_add_f32_dpp v47, v31, v47 quad_perm:[3,3,3,3] row_mask:0xf bank_mask:0xf
    v_max_f32 v84, v84, v47
    s_waitcnt vmcnt(30)
    v_mfma_f32_16x16x32_bf16 v[24:27], a[16:19], v[8:11], 0
    v_mfma_f32_16x16x32_bf16 v[24:27], a[20:23], v[12:15], v[24:27]
    s_add_u32 s29, s28, 4096
    buffer_load_dwordx4 a[16:19], v2, s[12:15], s29 offen offset:0 nt
    buffer_load_dwordx4 a[20:23], v2, s[12:15], s29 offen offset:256 nt
    v_mov_b32_dpp v48, v16 quad_perm:[0,0,0,0] row_mask:0xf bank_mask:0xf
    v_add_f32_dpp v48, v17, v48 quad_perm:[1,1,1,1] row_mask:0xf bank_mask:0xf
    v_add_f32_dpp v48, v18, v48 quad_perm:[2,2,2,2] row_mask:0xf bank_mask:0xf
    v_add_f32_dpp v48, v19, v48 quad_perm:[3,3,3,3] row_mask:0xf bank_mask:0xf
    v_max_f32 v84, v84, v48
    s_waitcnt vmcnt(30)
    v_mfma_f32_16x16x32_bf16 v[28:31], a[24:27], v[8:11], 0
    v_mfma_f32_16x16x32_bf16 v[28:31], a[28:31], v[12:15], v[28:31]
    buffer_load_dwordx4 a[24:27], v2, s[12:15], s29 offen offset:2048 nt
    buffer_load_dwordx4 a[28:31], v2, s[12:15], s29 offen offset:2304 nt
    v_mov_b32_dpp v49, v20 quad_perm:[0,0,0,0] row_mask:0xf bank_mask:0xf
    v_add_f32_dpp v49, v21, v49 quad_perm:[1,1,1,1] row_mask:0xf bank_mask:0xf
    v_add_f32_dpp v49, v22, v49 quad_perm:[2,2,2,2] row_mask:0xf bank_mask:0xf
    v_add_f32_dpp v49, v23, v49 quad_perm:[3,3,3,3] row_mask:0xf bank_mask:0xf
    v_max_f32 v84, v84, v49
    s_waitcnt vmcnt(30)
    v_mfma_f32_16x16x32_bf16 v[16:19], a[32:35], v[8:11], 0
    v_mfma_f32_16x16x32_bf16 v[16:19], a[36:39], v[12:15], v[16:19]
    s_add_u32 s29, s28, 8192
    buffer_load_dwordx4 a[32:35], v2, s[12:15], s29 offen offset:0 nt
    buffer_load_dwordx4 a[36:39], v2, s[12:15], s29 offen offset:256 nt
    v_mov_b32_dpp v50, v24 quad_perm:[0,0,0,0] row_mask:0xf bank_mask:0xf
    v_add_f32_dpp v50, v25, v50 quad_perm:[1,1,1,1] row_mask:0xf bank_mask:0xf
    v_add_f32_dpp v50, v26, v50 quad_perm:[2,2,2,2] row_mask:0xf bank_mask:0xf
    v_add_f32_dpp v50, v27, v50 quad_perm:[3,3,3,3] row_mask:0xf bank_mask:0xf
    v_max_f32 v84, v84, v50
    s_waitcnt vmcnt(30)
    v_mfma_f32_16x16x32_bf16 v[20:23], a[40:43], v[8:11], 0
    v_mfma_f32_16x16x32_bf16 v[20:23], a[44:47], v[12:15], v[20:23]
    buffer_load_dwordx4 a[40:43], v2, s[12:15], s29 offen offset:2048 nt
    buffer_load_dwordx4 a[44:47], v2, s[12:15], s29 offen offset:2304 nt
    v_mov_b32_dpp v51, v28 quad_perm:[0,0,0,0] row_mask:0xf bank_mask:0xf
    v_add_f32_dpp v51, v29, v51 quad_perm:[1,1,1,1] row_mask:0xf bank_mask:0xf
    v_add_f32_dpp v51, v30, v51 quad_perm:[2,2,2,2] row_mask:0xf bank_mask:0xf
    v_add_f32_dpp v51, v31, v51 quad_perm:[3,3,3,3] row_mask:0xf bank_mask:0xf
    v_max_f32 v84, v84, v51
    s_waitcnt vmcnt(30)
    v_mfma_f32_16x16x32_bf16 v[24:27], a[48:51], v[8:11], 0
    v_mfma_f32_16x16x32_bf16 v[24:27], a[52:55], v[12:15], v[24:27]
    s_add_u32 s29, s28, 12288
    buffer_load_dwordx4 a[48:51], v2, s[12:15], s29 offen offset:0 nt
    buffer_load_dwordx4 a[52:55], v2, s[12:15], s29 offen offset:256 nt
    v_mov_b32_dpp v52, v16 quad_perm:[0,0,0,0] row_mask:0xf bank_mask:0xf
    v_add_f32_dpp v52, v17, v52 quad_perm:[1,1,1,1] row_mask:0xf bank_mask:0xf
    v_add_f32_dpp v52, v18, v52 quad_perm:[2,2,2,2] row_mask:0xf bank_mask:0xf
    v_add_f32_dpp v52, v19, v52 quad_perm:[3,3,3,3] row_mask:0xf bank_mask:0xf
    v_max_f32 v84, v84, v52
    s_waitcnt vmcnt(30)
    v_mfma_f32_16x16x32_bf16 v[28:31], a[56:59], v[8:11], 0
    v_mfma_f32_16x16x32_bf16 v[28:31], a[60:63], v[12:15], v[28:31]
    buffer_load_dwordx4 a[56:59], v2, s[12:15], s29 offen offset:2048 nt
    buffer_load_dwordx4 a[60:63], v2, s[12:15], s29 offen offset:2304 nt
    v_mov_b32_dpp v53, v20 quad_perm:[0,0,0,0] row_mask:0xf bank_mask:0xf
    v_add_f32_dpp v53, v21, v53 quad_perm:[1,1,1,1] row_mask:0xf bank_mask:0xf
    v_add_f32_dpp v53, v22, v53 quad_perm:[2,2,2,2] row_mask:0xf bank_mask:0xf
    v_add_f32_dpp v53, v23, v53 quad_perm:[3,3,3,3] row_mask:0xf bank_mask:0xf
    v_max_f32 v84, v84, v53
    s_waitcnt vmcnt(30)
    v_mfma_f32_16x16x32_bf16 v[16:19], a[64:67], v[8:11], 0
    v_mfma_f32_16x16x32_bf16 v[16:19], a[68:71], v[12:15], v[16:19]
    s_add_u32 s29, s28, 16384
    buffer_load_dwordx4 a[64:67], v2, s[12:15], s29 offen offset:0 nt
    buffer_load_dwordx4 a[68:71], v2, s[12:15], s29 offen offset:256 nt
    v_mov_b32_dpp v54, v24 quad_perm:[0,0,0,0] row_mask:0xf bank_mask:0xf
    v_add_f32_dpp v54, v25, v54 quad_perm:[1,1,1,1] row_mask:0xf bank_mask:0xf
    v_add_f32_dpp v54, v26, v54 quad_perm:[2,2,2,2] row_mask:0xf bank_mask:0xf
    v_add_f32_dpp v54, v27, v54 quad_perm:[3,3,3,3] row_mask:0xf bank_mask:0xf
    v_max_f32 v84, v84, v54
    s_waitcnt vmcnt(30)
    v_mfma_f32_16x16x32_bf16 v[20:23], a[72:75], v[8:11], 0
    v_mfma_f32_16x16x32_bf16 v[20:23], a[76:79], v[12:15], v[20:23]
    buffer_load_dwordx4 a[72:75], v2, s[12:15], s29 offen offset:2048 nt
    buffer_load_dwordx4 a[76:79], v2, s[12:15], s29 offen offset:2304 nt
    v_mov_b32_dpp v55, v28 quad_perm:[0,0,0,0] row_mask:0xf bank_mask:0xf
    v_add_f32_dpp v55, v29, v55 quad_perm:[1,1,1,1] row_mask:0xf bank_mask:0xf
    v_add_f32_dpp v55, v30, v55 quad_perm:[2,2,2,2] row_mask:0xf bank_mask:0xf
    v_add_f32_dpp v55, v31, v55 quad_perm:[3,3,3,3] row_mask:0xf bank_mask:0xf
    v_max_f32 v84, v84, v55
    s_waitcnt vmcnt(30)
    v_mfma_f32_16x16x32_bf16 v[24:27], a[80:83], v[8:11], 0
    v_mfma_f32_16x16x32_bf16 v[24:27], a[84:87], v[12:15], v[24:27]
    s_add_u32 s29, s28, 20480
    buffer_load_dwordx4 a[80:83], v2, s[12:15], s29 offen offset:0 nt
    buffer_load_dwordx4 a[84:87], v2, s[12:15], s29 offen offset:256 nt
    v_mov_b32_dpp v56, v16 quad_perm:[0,0,0,0] row_mask:0xf bank_mask:0xf
    v_add_f32_dpp v56, v17, v56 quad_perm:[1,1,1,1] row_mask:0xf bank_mask:0xf
    v_add_f32_dpp v56, v18, v56 quad_perm:[2,2,2,2] row_mask:0xf bank_mask:0xf
    v_add_f32_dpp v56, v19, v56 quad_perm:[3,3,3,3] row_mask:0xf bank_mask:0xf
    v_max_f32 v84, v84, v56
    s_waitcnt vmcnt(30)
    v_mfma_f32_16x16x32_bf16 v[28:31], a[88:91], v[8:11], 0
    v_mfma_f32_16x16x32_bf16 v[28:31], a[92:95], v[12:15], v[28:31]
    buffer_load_dwordx4 a[88:91], v2, s[12:15], s29 offen offset:2048 nt
    buffer_load_dwordx4 a[92:95], v2, s[12:15], s29 offen offset:2304 nt
    v_mov_b32_dpp v57, v20 quad_perm:[0,0,0,0] row_mask:0xf bank_mask:0xf
    v_add_f32_dpp v57, v21, v57 quad_perm:[1,1,1,1] row_mask:0xf bank_mask:0xf
    v_add_f32_dpp v57, v22, v57 quad_perm:[2,2,2,2] row_mask:0xf bank_mask:0xf
    v_add_f32_dpp v57, v23, v57 quad_perm:[3,3,3,3] row_mask:0xf bank_mask:0xf
    v_max_f32 v84, v84, v57
    s_waitcnt vmcnt(30)
    v_mfma_f32_16x16x32_bf16 v[16:19], a[96:99], v[8:11], 0
    v_mfma_f32_16x16x32_bf16 v[16:19], a[100:103], v[12:15], v[16:19]
    s_add_u32 s29, s28, 24576
    buffer_load_dwordx4 a[96:99], v2, s[12:15], s29 offen offset:0 nt
    buffer_load_dwordx4 a[100:103], v2, s[12:15], s29 offen offset:256 nt
    v_mov_b32_dpp v58, v24 quad_perm:[0,0,0,0] row_mask:0xf bank_mask:0xf
    v_add_f32_dpp v58, v25, v58 quad_perm:[1,1,1,1] row_mask:0xf bank_mask:0xf
    v_add_f32_dpp v58, v26, v58 quad_perm:[2,2,2,2] row_mask:0xf bank_mask:0xf
    v_add_f32_dpp v58, v27, v58 quad_perm:[3,3,3,3] row_mask:0xf bank_mask:0xf
    v_max_f32 v84, v84, v58
    s_waitcnt vmcnt(30)
    v_mfma_f32_16x16x32_bf16 v[20:23], a[104:107], v[8:11], 0
    v_mfma_f32_16x16x32_bf16 v[20:23], a[108:111], v[12:15], v[20:23]
    buffer_load_dwordx4 a[104:107], v2, s[12:15], s29 offen offset:2048 nt
    buffer_load_dwordx4 a[108:111], v2, s[12:15], s29 offen offset:2304 nt
    v_mov_b32_dpp v59, v28 quad_perm:[0,0,0,0] row_mask:0xf bank_mask:0xf
    v_add_f32_dpp v59, v29, v59 quad_perm:[1,1,1,1] row_mask:0xf bank_mask:0xf
    v_add_f32_dpp v59, v30, v59 quad_perm:[2,2,2,2] row_mask:0xf bank_mask:0xf
    v_add_f32_dpp v59, v31, v59 quad_perm:[3,3,3,3] row_mask:0xf bank_mask:0xf
    v_max_f32 v84, v84, v59
    s_waitcnt vmcnt(30)
    v_mfma_f32_16x16x32_bf16 v[24:27], a[112:115], v[8:11], 0
    v_mfma_f32_16x16x32_bf16 v[24:27], a[116:119], v[12:15], v[24:27]
    s_add_u32 s29, s28, 28672
    buffer_load_dwordx4 a[112:115], v2, s[12:15], s29 offen offset:0 nt
    buffer_load_dwordx4 a[116:119], v2, s[12:15], s29 offen offset:256 nt
    v_mov_b32_dpp v60, v16 quad_perm:[0,0,0,0] row_mask:0xf bank_mask:0xf
    v_add_f32_dpp v60, v17, v60 quad_perm:[1,1,1,1] row_mask:0xf bank_mask:0xf
    v_add_f32_dpp v60, v18, v60 quad_perm:[2,2,2,2] row_mask:0xf bank_mask:0xf
    v_add_f32_dpp v60, v19, v60 quad_perm:[3,3,3,3] row_mask:0xf bank_mask:0xf
    v_max_f32 v84, v84, v60
    s_waitcnt vmcnt(30)
    v_mfma_f32_16x16x32_bf16 v[28:31], a[120:123], v[8:11], 0
    v_mfma_f32_16x16x32_bf16 v[28:31], a[124:127], v[12:15], v[28:31]
    buffer_load_dwordx4 a[120:123], v2, s[12:15], s29 offen offset:2048 nt
    buffer_load_dwordx4 a[124:127], v2, s[12:15], s29 offen offset:2304 nt
    v_mov_b32_dpp v61, v20 quad_perm:[0,0,0,0] row_mask:0xf bank_mask:0xf
    v_add_f32_dpp v61, v21, v61 quad_perm:[1,1,1,1] row_mask:0xf bank_mask:0xf
    v_add_f32_dpp v61, v22, v61 quad_perm:[2,2,2,2] row_mask:0xf bank_mask:0xf
    v_add_f32_dpp v61, v23, v61 quad_perm:[3,3,3,3] row_mask:0xf bank_mask:0xf
    v_max_f32 v84, v84, v61
    s_nop 7
    v_mov_b32_dpp v62, v24 quad_perm:[0,0,0,0] row_mask:0xf bank_mask:0xf
    v_add_f32_dpp v62, v25, v62 quad_perm:[1,1,1,1] row_mask:0xf bank_mask:0xf
    v_add_f32_dpp v62, v26, v62 quad_perm:[2,2,2,2] row_mask:0xf bank_mask:0xf
    v_add_f32_dpp v62, v27, v62 quad_perm:[3,3,3,3] row_mask:0xf bank_mask:0xf
    v_max_f32 v84, v84, v62
    v_mov_b32_dpp v63, v28 quad_perm:[0,0,0,0] row_mask:0xf bank_mask:0xf
    v_add_f32_dpp v63, v29, v63 quad_perm:[1,1,1,1] row_mask:0xf bank_mask:0xf
    v_add_f32_dpp v63, v30, v63 quad_perm:[2,2,2,2] row_mask:0xf bank_mask:0xf
    v_add_f32_dpp v63, v31, v63 quad_perm:[3,3,3,3] row_mask:0xf bank_mask:0xf
    v_max_f32 v84, v84, v63
    v_mov_b32 v85, v84
    s_nop 1
    v_permlane16_swap_b32 v84, v85
    s_nop 1
    v_max_f32 v84, v84, v85
    v_mov_b32 v85, v84
    s_nop 1
    v_permlane32_swap_b32 v84, v85
    s_nop 1
    v_max_f32 v84, v84, v85
    v_cvt_pk_bf16_f32 v84, v84, v84
    v_lshlrev_b32 v84, 16, v84
    v_mov_b32 v86, 0
    v_mov_b32 v87, 0
    v_cvt_pk_bf16_f32 v85, v32, v33
    v_lshlrev_b32 v32, 16, v85
    v_and_b32 v33, 0xffff0000, v85
    v_sub_f32 v32, v32, v84
    v_sub_f32 v33, v33, v84
    v_mul_f32 v32, s63, v32
    v_mul_f32 v33, s63, v33
    v_exp_f32 v32, v32
    v_exp_f32 v33, v33
    s_nop 0
    v_add_f32 v86, v86, v32
    v_add_f32 v87, v87, v33
    v_cvt_pk_bf16_f32 v85, v34, v35
    v_lshlrev_b32 v34, 16, v85
    v_and_b32 v35, 0xffff0000, v85
    v_sub_f32 v34, v34, v84
    v_sub_f32 v35, v35, v84
    v_mul_f32 v34, s63, v34
    v_mul_f32 v35, s63, v35
    v_exp_f32 v34, v34
    v_exp_f32 v35, v35
    s_nop 0
    v_add_f32 v86, v86, v34
    v_add_f32 v87, v87, v35
    v_cvt_pk_bf16_f32 v85, v36, v37
    v_lshlrev_b32 v36, 16, v85
    v_and_b32 v37, 0xffff0000, v85
    v_sub_f32 v36, v36, v84
    v_sub_f32 v37, v37, v84
    v_mul_f32 v36, s63, v36
    v_mul_f32 v37, s63, v37
    v_exp_f32 v36, v36
    v_exp_f32 v37, v37
    s_nop 0
    v_add_f32 v86, v86, v36
    v_add_f32 v87, v87, v37
    v_cvt_pk_bf16_f32 v85, v38, v39
    v_lshlrev_b32 v38, 16, v85
    v_and_b32 v39, 0xffff0000, v85
    v_sub_f32 v38, v38, v84
    v_sub_f32 v39, v39, v84
    v_mul_f32 v38, s63, v38
    v_mul_f32 v39, s63, v39
    v_exp_f32 v38, v38
    v_exp_f32 v39, v39
    s_nop 0
    v_add_f32 v86, v86, v38
    v_add_f32 v87, v87, v39
    v_cvt_pk_bf16_f32 v85, v40, v41
    v_lshlrev_b32 v40, 16, v85
    v_and_b32 v41, 0xffff0000, v85
    v_sub_f32 v40, v40, v84
    v_sub_f32 v41, v41, v84
    v_mul_f32 v40, s63, v40
    v_mul_f32 v41, s63, v41
    v_exp_f32 v40, v40
    v_exp_f32 v41, v41
    s_nop 0
    v_add_f32 v86, v86, v40
    v_add_f32 v87, v87, v41
    v_cvt_pk_bf16_f32 v85, v42, v43
    v_lshlrev_b32 v42, 16, v85
    v_and_b32 v43, 0xffff0000, v85
    v_sub_f32 v42, v42, v84
    v_sub_f32 v43, v43, v84
    v_mul_f32 v42, s63, v42
    v_mul_f32 v43, s63, v43
    v_exp_f32 v42, v42
    v_exp_f32 v43, v43
    s_nop 0
    v_add_f32 v86, v86, v42
    v_add_f32 v87, v87, v43
    v_cvt_pk_bf16_f32 v85, v44, v45
    v_lshlrev_b32 v44, 16, v85
    v_and_b32 v45, 0xffff0000, v85
    v_sub_f32 v44, v44, v84
    v_sub_f32 v45, v45, v84
    v_mul_f32 v44, s63, v44
    v_mul_f32 v45, s63, v45
    v_exp_f32 v44, v44
    v_exp_f32 v45, v45
    s_nop 0
    v_add_f32 v86, v86, v44
    v_add_f32 v87, v87, v45
    v_cvt_pk_bf16_f32 v85, v46, v47
    v_lshlrev_b32 v46, 16, v85
    v_and_b32 v47, 0xffff0000, v85
    v_sub_f32 v46, v46, v84
    v_sub_f32 v47, v47, v84
    v_mul_f32 v46, s63, v46
    v_mul_f32 v47, s63, v47
    v_exp_f32 v46, v46
    v_exp_f32 v47, v47
    s_nop 0
    v_add_f32 v86, v86, v46
    v_add_f32 v87, v87, v47
    v_cvt_pk_bf16_f32 v85, v48, v49
    v_lshlrev_b32 v48, 16, v85
    v_and_b32 v49, 0xffff0000, v85
    v_sub_f32 v48, v48, v84
    v_sub_f32 v49, v49, v84
    v_mul_f32 v48, s63, v48
    v_mul_f32 v49, s63, v49
    v_exp_f32 v48, v48
    v_exp_f32 v49, v49
    s_nop 0
    v_add_f32 v86, v86, v48
    v_add_f32 v87, v87, v49
    v_cvt_pk_bf16_f32 v85, v50, v51
    v_lshlrev_b32 v50, 16, v85
    v_and_b32 v51, 0xffff0000, v85
    v_sub_f32 v50, v50, v84
    v_sub_f32 v51, v51, v84
    v_mul_f32 v50, s63, v50
    v_mul_f32 v51, s63, v51
    v_exp_f32 v50, v50
    v_exp_f32 v51, v51
    s_nop 0
    v_add_f32 v86, v86, v50
    v_add_f32 v87, v87, v51
    v_cvt_pk_bf16_f32 v85, v52, v53
    v_lshlrev_b32 v52, 16, v85
    v_and_b32 v53, 0xffff0000, v85
    v_sub_f32 v52, v52, v84
    v_sub_f32 v53, v53, v84
    v_mul_f32 v52, s63, v52
    v_mul_f32 v53, s63, v53
    v_exp_f32 v52, v52
    v_exp_f32 v53, v53
    s_nop 0
    v_add_f32 v86, v86, v52
    v_add_f32 v87, v87, v53
    v_cvt_pk_bf16_f32 v85, v54, v55
    v_lshlrev_b32 v54, 16, v85
    v_and_b32 v55, 0xffff0000, v85
    v_sub_f32 v54, v54, v84
    v_sub_f32 v55, v55, v84
    v_mul_f32 v54, s63, v54
    v_mul_f32 v55, s63, v55
    v_exp_f32 v54, v54
    v_exp_f32 v55, v55
    s_nop 0
    v_add_f32 v86, v86, v54
    v_add_f32 v87, v87, v55
    v_cvt_pk_bf16_f32 v85, v56, v57
    v_lshlrev_b32 v56, 16, v85
    v_and_b32 v57, 0xffff0000, v85
    v_sub_f32 v56, v56, v84
    v_sub_f32 v57, v57, v84
    v_mul_f32 v56, s63, v56
    v_mul_f32 v57, s63, v57
    v_exp_f32 v56, v56
    v_exp_f32 v57, v57
    s_nop 0
    v_add_f32 v86, v86, v56
    v_add_f32 v87, v87, v57
    v_cvt_pk_bf16_f32 v85, v58, v59
    v_lshlrev_b32 v58, 16, v85
    v_and_b32 v59, 0xffff0000, v85
    v_sub_f32 v58, v58, v84
    v_sub_f32 v59, v59, v84
    v_mul_f32 v58, s63, v58
    v_mul_f32 v59, s63, v59
    v_exp_f32 v58, v58
    v_exp_f32 v59, v59
    s_nop 0
    v_add_f32 v86, v86, v58
    v_add_f32 v87, v87, v59
    v_cvt_pk_bf16_f32 v85, v60, v61
    v_lshlrev_b32 v60, 16, v85
    v_and_b32 v61, 0xffff0000, v85
    v_sub_f32 v60, v60, v84
    v_sub_f32 v61, v61, v84
    v_mul_f32 v60, s63, v60
    v_mul_f32 v61, s63, v61
    v_exp_f32 v60, v60
    v_exp_f32 v61, v61
    s_nop 0
    v_add_f32 v86, v86, v60
    v_add_f32 v87, v87, v61
    v_cvt_pk_bf16_f32 v85, v62, v63
    v_lshlrev_b32 v62, 16, v85
    v_and_b32 v63, 0xffff0000, v85
    v_sub_f32 v62, v62, v84
    v_sub_f32 v63, v63, v84
    v_mul_f32 v62, s63, v62
    v_mul_f32 v63, s63, v63
    v_exp_f32 v62, v62
    v_exp_f32 v63, v63
    s_nop 0
    v_add_f32 v86, v86, v62
    v_add_f32 v87, v87, v63
    v_add_f32 v86, v86, v87
    v_mov_b32 v85, v86
    s_nop 1
    v_permlane16_swap_b32 v86, v85
    s_nop 1
    v_add_f32 v86, v86, v85
    v_mov_b32 v85, v86
    s_nop 1
    v_permlane32_swap_b32 v86, v85
    s_nop 1
    v_add_f32 v86, v86, v85
    v_mov_b32 v94, v84
    v_mov_b32 v95, v86
    s_mov_b64 exec, 0x101
    ds_write_b64 v89, v[94:95]
    s_mov_b64 exec, -1
    v_cvt_pk_bf16_f32 v85, v32, v32
    v_and_b32 v68, v85, v64
    v_and_b32 v69, v85, v65
    v_and_b32 v70, v85, v66
    v_and_b32 v71, v85, v67
    v_cvt_pk_bf16_f32 v85, v33, v33
    v_and_b32 v72, v85, v64
    v_and_b32 v73, v85, v65
    v_and_b32 v74, v85, v66
    v_and_b32 v75, v85, v67
    s_waitcnt vmcnt(30)
    v_mfma_f32_16x16x32_bf16 v[76:79], v[68:71], a[0:3], 0
    v_mfma_f32_16x16x32_bf16 v[80:83], v[68:71], a[4:7], 0
    s_add_u32 s29, s28, 32768
    buffer_load_dwordx4 a[0:3], v2, s[12:15], s29 offen offset:0 nt
    buffer_load_dwordx4 a[4:7], v2, s[12:15], s29 offen offset:256 nt
    v_cvt_pk_bf16_f32 v85, v34, v34
    v_and_b32 v68, v85, v64
    v_and_b32 v69, v85, v65
    v_and_b32 v70, v85, v66
    v_and_b32 v71, v85, v67
    s_waitcnt vmcnt(30)
    v_mfma_f32_16x16x32_bf16 v[76:79], v[72:75], a[8:11], v[76:79]
    v_mfma_f32_16x16x32_bf16 v[80:83], v[72:75], a[12:15], v[80:83]
    buffer_load_dwordx4 a[8:11], v2, s[12:15], s29 offen offset:2048 nt
    buffer_load_dwordx4 a[12:15], v2, s[12:15], s29 offen offset:2304 nt
    v_cvt_pk_bf16_f32 v85, v35, v35
    v_and_b32 v72, v85, v64
    v_and_b32 v73, v85, v65
    v_and_b32 v74, v85, v66
    v_and_b32 v75, v85, v67
    s_waitcnt vmcnt(30)
    v_mfma_f32_16x16x32_bf16 v[76:79], v[68:71], a[16:19], v[76:79]
    v_mfma_f32_16x16x32_bf16 v[80:83], v[68:71], a[20:23], v[80:83]
    s_add_u32 s29, s28, 36864
    buffer_load_dwordx4 a[16:19], v2, s[12:15], s29 offen offset:0 nt
    buffer_load_dwordx4 a[20:23], v2, s[12:15], s29 offen offset:256 nt
    v_cvt_pk_bf16_f32 v85, v36, v36
    v_and_b32 v68, v85, v64
    v_and_b32 v69, v85, v65
    v_and_b32 v70, v85, v66
    v_and_b32 v71, v85, v67
    s_waitcnt vmcnt(30)
    v_mfma_f32_16x16x32_bf16 v[76:79], v[72:75], a[24:27], v[76:79]
    v_mfma_f32_16x16x32_bf16 v[80:83], v[72:75], a[28:31], v[80:83]
    buffer_load_dwordx4 a[24:27], v2, s[12:15], s29 offen offset:2048 nt
    buffer_load_dwordx4 a[28:31], v2, s[12:15], s29 offen offset:2304 nt
    v_cvt_pk_bf16_f32 v85, v37, v37
    v_and_b32 v72, v85, v64
    v_and_b32 v73, v85, v65
    v_and_b32 v74, v85, v66
    v_and_b32 v75, v85, v67
    s_waitcnt vmcnt(30)
    v_mfma_f32_16x16x32_bf16 v[76:79], v[68:71], a[32:35], v[76:79]
    v_mfma_f32_16x16x32_bf16 v[80:83], v[68:71], a[36:39], v[80:83]
    s_add_u32 s29, s28, 40960
    buffer_load_dwordx4 a[32:35], v2, s[12:15], s29 offen offset:0 nt
    buffer_load_dwordx4 a[36:39], v2, s[12:15], s29 offen offset:256 nt
    v_cvt_pk_bf16_f32 v85, v38, v38
    v_and_b32 v68, v85, v64
    v_and_b32 v69, v85, v65
    v_and_b32 v70, v85, v66
    v_and_b32 v71, v85, v67
    s_waitcnt vmcnt(30)
    v_mfma_f32_16x16x32_bf16 v[76:79], v[72:75], a[40:43], v[76:79]
    v_mfma_f32_16x16x32_bf16 v[80:83], v[72:75], a[44:47], v[80:83]
    buffer_load_dwordx4 a[40:43], v2, s[12:15], s29 offen offset:2048 nt
    buffer_load_dwordx4 a[44:47], v2, s[12:15], s29 offen offset:2304 nt
    v_cvt_pk_bf16_f32 v85, v39, v39
    v_and_b32 v72, v85, v64
    v_and_b32 v73, v85, v65
    v_and_b32 v74, v85, v66
    v_and_b32 v75, v85, v67
    s_waitcnt vmcnt(30)
    v_mfma_f32_16x16x32_bf16 v[76:79], v[68:71], a[48:51], v[76:79]
    v_mfma_f32_16x16x32_bf16 v[80:83], v[68:71], a[52:55], v[80:83]
    s_add_u32 s29, s28, 45056
    buffer_load_dwordx4 a[48:51], v2, s[12:15], s29 offen offset:0 nt
    buffer_load_dwordx4 a[52:55], v2, s[12:15], s29 offen offset:256 nt
    v_cvt_pk_bf16_f32 v85, v40, v40
    v_and_b32 v68, v85, v64
    v_and_b32 v69, v85, v65
    v_and_b32 v70, v85, v66
    v_and_b32 v71, v85, v67
    s_waitcnt vmcnt(30)
    v_mfma_f32_16x16x32_bf16 v[76:79], v[72:75], a[56:59], v[76:79]
    v_mfma_f32_16x16x32_bf16 v[80:83], v[72:75], a[60:63], v[80:83]
    buffer_load_dwordx4 a[56:59], v2, s[12:15], s29 offen offset:2048 nt
    buffer_load_dwordx4 a[60:63], v2, s[12:15], s29 offen offset:2304 nt
    v_cvt_pk_bf16_f32 v85, v41, v41
    v_and_b32 v72, v85, v64
    v_and_b32 v73, v85, v65
    v_and_b32 v74, v85, v66
    v_and_b32 v75, v85, v67
    s_waitcnt vmcnt(30)
    v_mfma_f32_16x16x32_bf16 v[76:79], v[68:71], a[64:67], v[76:79]
    v_mfma_f32_16x16x32_bf16 v[80:83], v[68:71], a[68:71], v[80:83]
    s_add_u32 s29, s28, 49152
    buffer_load_dwordx4 a[64:67], v2, s[12:15], s29 offen offset:0 nt
    buffer_load_dwordx4 a[68:71], v2, s[12:15], s29 offen offset:256 nt
    v_cvt_pk_bf16_f32 v85, v42, v42
    v_and_b32 v68, v85, v64
    v_and_b32 v69, v85, v65
    v_and_b32 v70, v85, v66
    v_and_b32 v71, v85, v67
    s_waitcnt vmcnt(30)
    v_mfma_f32_16x16x32_bf16 v[76:79], v[72:75], a[72:75], v[76:79]
    v_mfma_f32_16x16x32_bf16 v[80:83], v[72:75], a[76:79], v[80:83]
    buffer_load_dwordx4 a[72:75], v2, s[12:15], s29 offen offset:2048 nt
    buffer_load_dwordx4 a[76:79], v2, s[12:15], s29 offen offset:2304 nt
    v_cvt_pk_bf16_f32 v85, v43, v43
    v_and_b32 v72, v85, v64
    v_and_b32 v73, v85, v65
    v_and_b32 v74, v85, v66
    v_and_b32 v75, v85, v67
    s_waitcnt vmcnt(30)
    v_mfma_f32_16x16x32_bf16 v[76:79], v[68:71], a[80:83], v[76:79]
    v_mfma_f32_16x16x32_bf16 v[80:83], v[68:71], a[84:87], v[80:83]
    s_add_u32 s29, s28, 53248
    buffer_load_dwordx4 a[80:83], v2, s[12:15], s29 offen offset:0 nt
    buffer_load_dwordx4 a[84:87], v2, s[12:15], s29 offen offset:256 nt
    v_cvt_pk_bf16_f32 v85, v44, v44
    v_and_b32 v68, v85, v64
    v_and_b32 v69, v85, v65
    v_and_b32 v70, v85, v66
    v_and_b32 v71, v85, v67
    s_waitcnt vmcnt(30)
    v_mfma_f32_16x16x32_bf16 v[76:79], v[72:75], a[88:91], v[76:79]
    v_mfma_f32_16x16x32_bf16 v[80:83], v[72:75], a[92:95], v[80:83]
    buffer_load_dwordx4 a[88:91], v2, s[12:15], s29 offen offset:2048 nt
    buffer_load_dwordx4 a[92:95], v2, s[12:15], s29 offen offset:2304 nt
    v_cvt_pk_bf16_f32 v85, v45, v45
    v_and_b32 v72, v85, v64
    v_and_b32 v73, v85, v65
    v_and_b32 v74, v85, v66
    v_and_b32 v75, v85, v67
    s_waitcnt vmcnt(30)
    v_mfma_f32_16x16x32_bf16 v[76:79], v[68:71], a[96:99], v[76:79]
    v_mfma_f32_16x16x32_bf16 v[80:83], v[68:71], a[100:103], v[80:83]
    s_add_u32 s29, s28, 57344
    buffer_load_dwordx4 a[96:99], v2, s[12:15], s29 offen offset:0 nt
    buffer_load_dwordx4 a[100:103], v2, s[12:15], s29 offen offset:256 nt
    v_cvt_pk_bf16_f32 v85, v46, v46
    v_and_b32 v68, v85, v64
    v_and_b32 v69, v85, v65
    v_and_b32 v70, v85, v66
    v_and_b32 v71, v85, v67
    s_waitcnt vmcnt(30)
    v_mfma_f32_16x16x32_bf16 v[76:79], v[72:75], a[104:107], v[76:79]
    v_mfma_f32_16x16x32_bf16 v[80:83], v[72:75], a[108:111], v[80:83]
    buffer_load_dwordx4 a[104:107], v2, s[12:15], s29 offen offset:2048 nt
    buffer_load_dwordx4 a[108:111], v2, s[12:15], s29 offen offset:2304 nt
    v_cvt_pk_bf16_f32 v85, v47, v47
    v_and_b32 v72, v85, v64
    v_and_b32 v73, v85, v65
    v_and_b32 v74, v85, v66
    v_and_b32 v75, v85, v67
    s_waitcnt vmcnt(30)
    v_mfma_f32_16x16x32_bf16 v[76:79], v[68:71], a[112:115], v[76:79]
    v_mfma_f32_16x16x32_bf16 v[80:83], v[68:71], a[116:119], v[80:83]
    s_add_u32 s29, s28, 61440
    buffer_load_dwordx4 a[112:115], v2, s[12:15], s29 offen offset:0 nt
    buffer_load_dwordx4 a[116:119], v2, s[12:15], s29 offen offset:256 nt
    v_cvt_pk_bf16_f32 v85, v48, v48
    v_and_b32 v68, v85, v64
    v_and_b32 v69, v85, v65
    v_and_b32 v70, v85, v66
    v_and_b32 v71, v85, v67
    s_waitcnt vmcnt(30)
    v_mfma_f32_16x16x32_bf16 v[76:79], v[72:75], a[120:123], v[76:79]
    v_mfma_f32_16x16x32_bf16 v[80:83], v[72:75], a[124:127], v[80:83]
    buffer_load_dwordx4 a[120:123], v2, s[12:15], s29 offen offset:2048 nt
    buffer_load_dwordx4 a[124:127], v2, s[12:15], s29 offen offset:2304 nt
    v_cvt_pk_bf16_f32 v85, v49, v49
    v_and_b32 v72, v85, v64
    v_and_b32 v73, v85, v65
    v_and_b32 v74, v85, v66
    v_and_b32 v75, v85, v67
    s_waitcnt vmcnt(30)
    v_mfma_f32_16x16x32_bf16 v[76:79], v[68:71], a[0:3], v[76:79]
    v_mfma_f32_16x16x32_bf16 v[80:83], v[68:71], a[4:7], v[80:83]
    v_cvt_pk_bf16_f32 v85, v50, v50
    v_and_b32 v68, v85, v64
    v_and_b32 v69, v85, v65
    v_and_b32 v70, v85, v66
    v_and_b32 v71, v85, v67
    s_waitcnt vmcnt(28)
    v_mfma_f32_16x16x32_bf16 v[76:79], v[72:75], a[8:11], v[76:79]
    v_mfma_f32_16x16x32_bf16 v[80:83], v[72:75], a[12:15], v[80:83]
    v_cvt_pk_bf16_f32 v85, v51, v51
    v_and_b32 v72, v85, v64
    v_and_b32 v73, v85, v65
    v_and_b32 v74, v85, v66
    v_and_b32 v75, v85, v67
    s_waitcnt vmcnt(26)
    v_mfma_f32_16x16x32_bf16 v[76:79], v[68:71], a[16:19], v[76:79]
    v_mfma_f32_16x16x32_bf16 v[80:83], v[68:71], a[20:23], v[80:83]
    v_cvt_pk_bf16_f32 v85, v52, v52
    v_and_b32 v68, v85, v64
    v_and_b32 v69, v85, v65
    v_and_b32 v70, v85, v66
    v_and_b32 v71, v85, v67
    s_waitcnt vmcnt(24)
    v_mfma_f32_16x16x32_bf16 v[76:79], v[72:75], a[24:27], v[76:79]
    v_mfma_f32_16x16x32_bf16 v[80:83], v[72:75], a[28:31], v[80:83]
    v_cvt_pk_bf16_f32 v85, v53, v53
    v_and_b32 v72, v85, v64
    v_and_b32 v73, v85, v65
    v_and_b32 v74, v85, v66
    v_and_b32 v75, v85, v67
    s_waitcnt vmcnt(22)
    v_mfma_f32_16x16x32_bf16 v[76:79], v[68:71], a[32:35], v[76:79]
    v_mfma_f32_16x16x32_bf16 v[80:83], v[68:71], a[36:39], v[80:83]
    v_cvt_pk_bf16_f32 v85, v54, v54
    v_and_b32 v68, v85, v64
    v_and_b32 v69, v85, v65
    v_and_b32 v70, v85, v66
    v_and_b32 v71, v85, v67
    s_waitcnt vmcnt(20)
    v_mfma_f32_16x16x32_bf16 v[76:79], v[72:75], a[40:43], v[76:79]
    v_mfma_f32_16x16x32_bf16 v[80:83], v[72:75], a[44:47], v[80:83]
    v_cvt_pk_bf16_f32 v85, v55, v55
    v_and_b32 v72, v85, v64
    v_and_b32 v73, v85, v65
    v_and_b32 v74, v85, v66
    v_and_b32 v75, v85, v67
    s_waitcnt vmcnt(18)
    v_mfma_f32_16x16x32_bf16 v[76:79], v[68:71], a[48:51], v[76:79]
    v_mfma_f32_16x16x32_bf16 v[80:83], v[68:71], a[52:55], v[80:83]
    v_cvt_pk_bf16_f32 v85, v56, v56
    v_and_b32 v68, v85, v64
    v_and_b32 v69, v85, v65
    v_and_b32 v70, v85, v66
    v_and_b32 v71, v85, v67
    s_waitcnt vmcnt(16)
    v_mfma_f32_16x16x32_bf16 v[76:79], v[72:75], a[56:59], v[76:79]
    v_mfma_f32_16x16x32_bf16 v[80:83], v[72:75], a[60:63], v[80:83]
    v_cvt_pk_bf16_f32 v85, v57, v57
    v_and_b32 v72, v85, v64
    v_and_b32 v73, v85, v65
    v_and_b32 v74, v85, v66
    v_and_b32 v75, v85, v67
    s_waitcnt vmcnt(14)
    v_mfma_f32_16x16x32_bf16 v[76:79], v[68:71], a[64:67], v[76:79]
    v_mfma_f32_16x16x32_bf16 v[80:83], v[68:71], a[68:71], v[80:83]
    v_cvt_pk_bf16_f32 v85, v58, v58
    v_and_b32 v68, v85, v64
    v_and_b32 v69, v85, v65
    v_and_b32 v70, v85, v66
    v_and_b32 v71, v85, v67
    s_waitcnt vmcnt(12)
    v_mfma_f32_16x16x32_bf16 v[76:79], v[72:75], a[72:75], v[76:79]
    v_mfma_f32_16x16x32_bf16 v[80:83], v[72:75], a[76:79], v[80:83]
    v_cvt_pk_bf16_f32 v85, v59, v59
    v_and_b32 v72, v85, v64
    v_and_b32 v73, v85, v65
    v_and_b32 v74, v85, v66
    v_and_b32 v75, v85, v67
    s_waitcnt vmcnt(10)
    v_mfma_f32_16x16x32_bf16 v[76:79], v[68:71], a[80:83], v[76:79]
    v_mfma_f32_16x16x32_bf16 v[80:83], v[68:71], a[84:87], v[80:83]
    v_cvt_pk_bf16_f32 v85, v60, v60
    v_and_b32 v68, v85, v64
    v_and_b32 v69, v85, v65
    v_and_b32 v70, v85, v66
    v_and_b32 v71, v85, v67
    s_waitcnt vmcnt(8)
    v_mfma_f32_16x16x32_bf16 v[76:79], v[72:75], a[88:91], v[76:79]
    v_mfma_f32_16x16x32_bf16 v[80:83], v[72:75], a[92:95], v[80:83]
    v_cvt_pk_bf16_f32 v85, v61, v61
    v_and_b32 v72, v85, v64
    v_and_b32 v73, v85, v65
    v_and_b32 v74, v85, v66
    v_and_b32 v75, v85, v67
    s_waitcnt vmcnt(6)
    v_mfma_f32_16x16x32_bf16 v[76:79], v[68:71], a[96:99], v[76:79]
    v_mfma_f32_16x16x32_bf16 v[80:83], v[68:71], a[100:103], v[80:83]
    v_cvt_pk_bf16_f32 v85, v62, v62
    v_and_b32 v68, v85, v64
    v_and_b32 v69, v85, v65
    v_and_b32 v70, v85, v66
    v_and_b32 v71, v85, v67
    s_waitcnt vmcnt(4)
    v_mfma_f32_16x16x32_bf16 v[76:79], v[72:75], a[104:107], v[76:79]
    v_mfma_f32_16x16x32_bf16 v[80:83], v[72:75], a[108:111], v[80:83]
    v_cvt_pk_bf16_f32 v85, v63, v63
    v_and_b32 v72, v85, v64
    v_and_b32 v73, v85, v65
    v_and_b32 v74, v85, v66
    v_and_b32 v75, v85, v67
    s_waitcnt vmcnt(2)
    v_mfma_f32_16x16x32_bf16 v[76:79], v[68:71], a[112:115], v[76:79]
    v_mfma_f32_16x16x32_bf16 v[80:83], v[68:71], a[116:119], v[80:83]
    s_waitcnt vmcnt(0)
    v_mfma_f32_16x16x32_bf16 v[76:79], v[72:75], a[120:123], v[76:79]
    v_mfma_f32_16x16x32_bf16 v[80:83], v[72:75], a[124:127], v[80:83]
    s_nop 7
    ds_write_b128 v88, v[76:79]
    ds_write_b128 v88, v[80:83] offset:512
    s_waitcnt lgkmcnt(0)
    s_barrier
    s_cmp_gt_u32 s3, 1
    s_cbranch_scc1 L_pub_done
    ds_read_b128 v[16:19], v91 offset:0
    ds_read_b128 v[20:23], v91 offset:16
    ds_read_b128 v[24:27], v91 offset:32
    ds_read_b128 v[28:31], v91 offset:48
    ds_read_b128 v[32:35], v90 offset:0
    ds_read_b128 v[36:39], v90 offset:2048
    ds_read_b128 v[40:43], v90 offset:4096
    ds_read_b128 v[44:47], v90 offset:6144
    ds_read_b128 v[48:51], v90 offset:8192
    ds_read_b128 v[52:55], v90 offset:10240
    ds_read_b128 v[56:59], v90 offset:12288
    ds_read_b128 v[60:63], v90 offset:14336
    v_mov_b32 v10, 0
    s_waitcnt lgkmcnt(8)
    v_max3_f32 v8, v16, v18, v20
    v_max3_f32 v9, v22, v24, v26
    v_max3_f32 v8, v8, v28, v30
    v_max_f32 v8, v8, v9
    v_sub_f32 v16, v16, v8
    v_sub_f32 v18, v18, v8
    v_sub_f32 v20, v20, v8
    v_sub_f32 v22, v22, v8
    v_sub_f32 v24, v24, v8
    v_sub_f32 v26, v26, v8
    v_sub_f32 v28, v28, v8
    v_sub_f32 v30, v30, v8
    v_mul_f32 v16, s63, v16
    v_mul_f32 v18, s63, v18
    v_mul_f32 v20, s63, v20
    v_mul_f32 v22, s63, v22
    v_mul_f32 v24, s63, v24
    v_mul_f32 v26, s63, v26
    v_mul_f32 v28, s63, v28
    v_mul_f32 v30, s63, v30
    v_exp_f32 v16, v16
    v_exp_f32 v18, v18
    v_exp_f32 v20, v20
    v_exp_f32 v22, v22
    v_exp_f32 v24, v24
    v_exp_f32 v26, v26
    v_exp_f32 v28, v28
    v_exp_f32 v30, v30
    s_nop 0
    v_mul_f32 v9, v16, v17
    v_fma_f32 v9, v18, v19, v9
    v_fma_f32 v9, v20, v21, v9
    v_fma_f32 v9, v22, v23, v9
    v_fma_f32 v9, v24, v25, v9
    v_fma_f32 v9, v26, v27, v9
    v_fma_f32 v9, v28, v29, v9
    v_fma_f32 v9, v30, v31, v9
    v_perm_b32 v68, v9, v8, s58
    v_perm_b32 v69, v10, v8, s59
    v_perm_b32 v70, v10, v8, s60
    v_add3_u32 v71, v68, v69, v70
    v_sub_u32 v71, s6, v71
    s_waitcnt lgkmcnt(0)
    v_pk_mul_f32 v[12:13], v[16:17], v[32:33] op_sel_hi:[0,1]
    v_pk_mul_f32 v[14:15], v[16:17], v[34:35] op_sel_hi:[0,1]
    v_pk_fma_f32 v[12:13], v[18:19], v[36:37], v[12:13] op_sel_hi:[0,1,1]
    v_pk_fma_f32 v[14:15], v[18:19], v[38:39], v[14:15] op_sel_hi:[0,1,1]
    v_pk_fma_f32 v[12:13], v[20:21], v[40:41], v[12:13] op_sel_hi:[0,1,1]
    v_pk_fma_f32 v[14:15], v[20:21], v[42:43], v[14:15] op_sel_hi:[0,1,1]
    v_pk_fma_f32 v[12:13], v[22:23], v[44:45], v[12:13] op_sel_hi:[0,1,1]
    v_pk_fma_f32 v[14:15], v[22:23], v[46:47], v[14:15] op_sel_hi:[0,1,1]
    v_pk_fma_f32 v[12:13], v[24:25], v[48:49], v[12:13] op_sel_hi:[0,1,1]
    v_pk_fma_f32 v[14:15], v[24:25], v[50:51], v[14:15] op_sel_hi:[0,1,1]
    v_pk_fma_f32 v[12:13], v[26:27], v[52:53], v[12:13] op_sel_hi:[0,1,1]
    v_pk_fma_f32 v[14:15], v[26:27], v[54:55], v[14:15] op_sel_hi:[0,1,1]
    v_pk_fma_f32 v[12:13], v[28:29], v[56:57], v[12:13] op_sel_hi:[0,1,1]
    v_pk_fma_f32 v[14:15], v[28:29], v[58:59], v[14:15] op_sel_hi:[0,1,1]
    v_pk_fma_f32 v[12:13], v[30:31], v[60:61], v[12:13] op_sel_hi:[0,1,1]
    v_pk_fma_f32 v[14:15], v[30:31], v[62:63], v[14:15] op_sel_hi:[0,1,1]
    v_perm_b32 v64, v12, v15, s58
    v_perm_b32 v65, v13, v15, s59
    v_perm_b32 v66, v14, v15, s60
    v_add3_u32 v67, v64, v65, v66
    v_sub_u32 v67, s6, v67
    buffer_store_dwordx4 v[64:67], v92, s[16:19], 0 offen sc1
    s_mov_b64 exec, 1
    buffer_store_dwordx4 v[68:71], v92, s[16:19], 0 offen offset:1024 sc1
    s_mov_b64 exec, -1
L_pub_done:
    s_cmp_eq_u32 s68, 0
    s_cbranch_scc1 L_end
    s_lshl_b32 s30, s3, 6
    v_add_u32 v10, s30, v0
    s_lshl_b32 s71, s3, 10
    s_cmp_eq_u32 s68, 2
    s_cbranch_scc1 Ldma_s3_13
    s_mov_b32 s20, s40
    s_mov_b32 s21, s41
    s_mov_b32 s22, 0x380000
    s_mov_b32 s23, 0x20000
    s_lshr_b32 s30, s69, 2
    s_mul_i32 s30, s30, 229376
    s_and_b32 s31, s69, 3
    s_mul_i32 s31, s31, 224
    s_add_u32 s70, s30, s31
    s_movk_i32 s31, 18725
    v_add_u32 v11, 0, v10
    v_mul_lo_u32 v12, v11, s31
    v_lshrrev_b32 v12, 18, v12
    v_mul_u32_u24 v13, 14, v12
    v_sub_u32 v13, v11, v13
    v_mul_u32_u24 v12, 0x380, v12
    v_lshl_add_u32 v12, v13, 4, v12
    s_add_u32 m0, s71, 0
    s_nop 0
    buffer_load_dwordx4 v12, s[20:23], s70 offen nt lds
    v_add_u32 v11, 512, v10
    v_mul_lo_u32 v12, v11, s31
    v_lshrrev_b32 v12, 18, v12
    v_mul_u32_u24 v13, 14, v12
    v_sub_u32 v13, v11, v13
    v_mul_u32_u24 v12, 0x380, v12
    v_lshl_add_u32 v12, v13, 4, v12
    s_add_u32 m0, s71, 8192
    s_nop 0
    buffer_load_dwordx4 v12, s[20:23], s70 offen nt lds
    v_add_u32 v11, 1024, v10
    v_mul_lo_u32 v12, v11, s31
    v_lshrrev_b32 v12, 18, v12
    v_mul_u32_u24 v13, 14, v12
    v_sub_u32 v13, v11, v13
    v_mul_u32_u24 v12, 0x380, v12
    v_lshl_add_u32 v12, v13, 4, v12
    s_add_u32 m0, s71, 16384
    s_nop 0
    s_waitcnt vmcnt(1)
    buffer_load_dwordx4 v12, s[20:23], s70 offen nt lds
    v_add_u32 v11, 1536, v10
    v_mul_lo_u32 v12, v11, s31
    v_lshrrev_b32 v12, 18, v12
    v_mul_u32_u24 v13, 14, v12
    v_sub_u32 v13, v11, v13
    v_mul_u32_u24 v12, 0x380, v12
    v_lshl_add_u32 v12, v13, 4, v12
    s_add_u32 m0, s71, 24576
    s_nop 0
    s_waitcnt vmcnt(1)
    buffer_load_dwordx4 v12, s[20:23], s70 offen nt lds
    v_add_u32 v11, 2048, v10
    v_mul_lo_u32 v12, v11, s31
    v_lshrrev_b32 v12, 18, v12
    v_mul_u32_u24 v13, 14, v12
    v_sub_u32 v13, v11, v13
    v_mul_u32_u24 v12, 0x380, v12
    v_lshl_add_u32 v12, v13, 4, v12
    s_add_u32 m0, s71, 32768
    s_nop 0
    s_waitcnt vmcnt(1)
    buffer_load_dwordx4 v12, s[20:23], s70 offen nt lds
    v_add_u32 v11, 2560, v10
    v_mul_lo_u32 v12, v11, s31
    v_lshrrev_b32 v12, 18, v12
    v_mul_u32_u24 v13, 14, v12
    v_sub_u32 v13, v11, v13
    v_mul_u32_u24 v12, 0x380, v12
    v_lshl_add_u32 v12, v13, 4, v12
    s_add_u32 m0, s71, 40960
    s_nop 0
    s_waitcnt vmcnt(1)
    buffer_load_dwordx4 v12, s[20:23], s70 offen nt lds
    v_add_u32 v11, 3072, v10
    v_mul_lo_u32 v12, v11, s31
    v_lshrrev_b32 v12, 18, v12
    v_mul_u32_u24 v13, 14, v12
    v_sub_u32 v13, v11, v13
    v_mul_u32_u24 v12, 0x380, v12
    v_lshl_add_u32 v12, v13, 4, v12
    s_add_u32 m0, s71, 49152
    s_nop 0
    s_waitcnt vmcnt(1)
    buffer_load_dwordx4 v12, s[20:23], s70 offen nt lds
    s_branch Ldma_done_12
Ldma_s3_13:
    v_lshrrev_b32 v11, 2, v10
    v_mul_u32_u24 v11, 0xe00, v11
    v_and_b32 v12, 3, v10
    v_lshl_add_u32 v11, v12, 4, v11
    s_lshl_b32 s70, s69, 6
    s_mov_b32 s20, s44
    s_mov_b32 s21, s45
    s_mov_b32 s22, 0x188000
    s_mov_b32 s23, 0x20000
    s_add_u32 s30, s70, 0
    s_add_u32 m0, s71, 0
    s_nop 0
    buffer_load_dwordx4 v11, s[20:23], s30 offen nt lds
    s_add_u32 s30, s70, 458752
    s_add_u32 m0, s71, 8192
    s_nop 0
    buffer_load_dwordx4 v11, s[20:23], s30 offen nt lds
    s_add_u32 s30, s70, 917504
    s_add_u32 m0, s71, 16384
    s_nop 0
    s_waitcnt vmcnt(1)
    buffer_load_dwordx4 v11, s[20:23], s30 offen nt lds
    s_cmp_gt_u32 s3, 3
    s_cbranch_scc1 Lskip_14
    s_add_u32 s30, s70, 1376256
    s_add_u32 m0, s71, 24576
    s_nop 0
    s_waitcnt vmcnt(1)
    buffer_load_dwordx4 v11, s[20:23], s30 offen nt lds
Lskip_14:
    s_mov_b32 s20, s46
    s_mov_b32 s21, s47
    s_mov_b32 s22, 0x188000
    s_mov_b32 s23, 0x20000
    s_add_u32 s30, s70, 0
    s_add_u32 m0, s71, 28672
    s_nop 0
    s_waitcnt vmcnt(1)
    buffer_load_dwordx4 v11, s[20:23], s30 offen nt lds
    s_add_u32 s30, s70, 458752
    s_add_u32 m0, s71, 36864
    s_nop 0
    s_waitcnt vmcnt(1)
    buffer_load_dwordx4 v11, s[20:23], s30 offen nt lds
    s_add_u32 s30, s70, 917504
    s_add_u32 m0, s71, 45056
    s_nop 0
    s_waitcnt vmcnt(1)
    buffer_load_dwordx4 v11, s[20:23], s30 offen nt lds
    s_cmp_gt_u32 s3, 3
    s_cbranch_scc1 Lskip_15
    s_add_u32 s30, s70, 1376256
    s_add_u32 m0, s71, 53248
    s_nop 0
    s_waitcnt vmcnt(1)
    buffer_load_dwordx4 v11, s[20:23], s30 offen nt lds
Lskip_15:
    s_mov_b32 s20, s48
    s_mov_b32 s21, s49
    s_mov_b32 s22, 0x188000
    s_mov_b32 s23, 0x20000
    v_lshlrev_b32 v11, 4, v10
    s_mul_i32 s70, s69, 28672
    s_add_u32 s30, s70, 0
    s_add_u32 m0, s71, 57344
    s_nop 0
    s_waitcnt vmcnt(1)
    buffer_load_dwordx4 v11, s[20:23], s30 offen nt lds
    s_add_u32 s30, s70, 8192
    s_add_u32 m0, s71, 65536
    s_nop 0
    s_waitcnt vmcnt(1)
    buffer_load_dwordx4 v11, s[20:23], s30 offen nt lds
    s_add_u32 s30, s70, 16384
    s_add_u32 m0, s71, 73728
    s_nop 0
    s_waitcnt vmcnt(1)
    buffer_load_dwordx4 v11, s[20:23], s30 offen nt lds
    s_cmp_gt_u32 s3, 3
    s_cbranch_scc1 Lskip_16
    s_add_u32 s30, s70, 24576
    s_add_u32 m0, s71, 81920
    s_nop 0
    s_waitcnt vmcnt(1)
    buffer_load_dwordx4 v11, s[20:23], s30 offen nt lds
Lskip_16:
Ldma_done_12:
    s_cmp_eq_u32 s68, 2
    s_cbranch_scc1 L_s3
    s_lshr_b32 s72, s69, 2
    s_mul_i32 s30, s72, 36864
    s_add_u32 s30, s30, 131072
    v_and_b32 v7, 31, v0
    v_mul_u32_u24 v7, 1152, v7
    v_add_u32 v7, s30, v7
    s_mul_i32 s31, s3, 4608
    s_add_u32 s30, s30, s31
    v_lshlrev_b32 v5, 4, v0
    v_add_u32 v6, s30, v5
    v_add_u32 v9, 2304, v6
    v_bfe_u32 v3, v0, 2, 2
    v_lshrrev_b32 v4, 4, v0
    v_lshl_add_u32 v3, v4, 3, v3
    v_mul_u32_u24 v3, 224, v3
    v_and_b32 v11, 3, v0
    v_lshl_add_u32 v3, v11, 3, v3
    s_lshl_b32 s30, s3, 5
    s_add_u32 s30, s30, 0
    v_add_u32 v3, s30, v3
    s_lshl_b32 s30, s3, 10
    s_add_u32 s31, s30, 86016
    v_add_u32 v72, s31, v5
    v_bfe_u32 v73, v0, 1, 3
    v_lshlrev_b32 v73, 7, v73
    v_lshl_add_u32 v73, v4, 5, v73
    v_and_b32 v11, 1, v0
    v_lshl_add_u32 v73, v11, 4, v73
    v_add_u32 v73, 86016, v73
    s_and_b32 s30, s69, 3
    s_mul_i32 s30, s30, 448
    s_lshl_b32 s31, s3, 6
    s_add_u32 s30, s30, s31
    s_mul_i32 s31, s72, 2048
    s_add_u32 s30, s30, s31
    s_add_u32 s30, s30, 1048576
    v_lshlrev_b32 v77, 2, v0
    v_add_u32 v77, s30, v77
    s_mov_b32 s66, 0x88888888
    s_mov_b32 s67, 0x88888888
    v_and_b32 v78, 3, v0
    v_add_u32 v78, 0x07060501, v78
    v_mov_b32 v79, 0x0c0c0c0c
    v_cndmask_b32 v78, v78, v79, s[66:67]
    v_mov_b32 v79, s6
    s_lshl_b32 s70, s3, 2
    s_add_u32 s71, s70, 1
    s_add_u32 s73, s70, 2
    s_add_u32 s78, s70, 3
    s_waitcnt vmcnt(0)
    s_barrier
    s_cmp_gt_u32 s3, 6
    s_cbranch_scc1 L_s2_now
    ds_read_b64_tr_b16 a[0:1], v3 offset:0
    ds_read_b64_tr_b16 a[2:3], v3 offset:896
    ds_read_b64_tr_b16 a[4:5], v3 offset:7168
    ds_read_b64_tr_b16 a[6:7], v3 offset:8064
    ds_read_b64_tr_b16 a[8:9], v3 offset:14336
    ds_read_b64_tr_b16 a[10:11], v3 offset:15232
    ds_read_b64_tr_b16 a[12:13], v3 offset:21504
    ds_read_b64_tr_b16 a[14:15], v3 offset:22400
    ds_read_b64_tr_b16 a[16:17], v3 offset:28672
    ds_read_b64_tr_b16 a[18:19], v3 offset:29568
    ds_read_b64_tr_b16 a[20:21], v3 offset:35840
    ds_read_b64_tr_b16 a[22:23], v3 offset:36736
    ds_read_b64_tr_b16 a[24:25], v3 offset:43008
    ds_read_b64_tr_b16 a[26:27], v3 offset:43904
    ds_read_b64_tr_b16 a[28:29], v3 offset:50176
    ds_read_b64_tr_b16 a[30:31], v3 offset:51072
L_s2_now:
    s_mov_b32 s7, 0
    buffer_load_dwordx4 v[48:51], v7, s[16:19], 0 offen offset:1024 sc1
    buffer_load_dwordx4 v[32:35], v6, s[16:19], 0 offen offset:0 sc1
    buffer_load_dwordx4 v[36:39], v6, s[16:19], 0 offen offset:1152 sc1
    buffer_load_dwordx4 v[40:43], v9, s[16:19], 0 offen offset:0 sc1
    buffer_load_dwordx4 v[44:47], v9, s[16:19], 0 offen offset:1152 sc1
    s_branch Lpoll_17w
Lpoll_17:
    s_cmp_eq_u64 s[32:33], 0
    s_cbranch_scc1 Lsk_19
    s_mov_b64 exec, s[32:33]
    buffer_load_dwordx4 v[48:51], v7, s[16:19], 0 offen offset:1024 sc1
Lsk_19:
    s_cmp_eq_u64 s[34:35], 0
    s_cbranch_scc1 Lsk_20
    s_mov_b64 exec, s[34:35]
    buffer_load_dwordx4 v[32:35], v6, s[16:19], 0 offen offset:0 sc1
Lsk_20:
    s_cmp_eq_u64 s[36:37], 0
    s_cbranch_scc1 Lsk_21
    s_mov_b64 exec, s[36:37]
    buffer_load_dwordx4 v[36:39], v6, s[16:19], 0 offen offset:1152 sc1
Lsk_21:
    s_cmp_eq_u64 s[38:39], 0
    s_cbranch_scc1 Lsk_22
    s_mov_b64 exec, s[38:39]
    buffer_load_dwordx4 v[40:43], v9, s[16:19], 0 offen offset:0 sc1
Lsk_22:
    s_cmp_eq_u64 s[40:41], 0
    s_cbranch_scc1 Lsk_23
    s_mov_b64 exec, s[40:41]
    buffer_load_dwordx4 v[44:47], v9, s[16:19], 0 offen offset:1152 sc1
Lsk_23:
    s_mov_b64 exec, -1
Lpoll_17w:
    s_waitcnt vmcnt(0)
    v_add3_u32 v52, v48, v49, v50
    v_add3_u32 v53, v32, v33, v34
    v_add3_u32 v54, v36, v37, v38
    v_add3_u32 v55, v40, v41, v42
    v_add3_u32 v56, v44, v45, v46
    v_add3_u32 v52, v52, v51, s57
    v_add3_u32 v53, v53, v35, s57
    v_add3_u32 v54, v54, v39, s57
    v_add3_u32 v55, v55, v43, s57
    v_add3_u32 v56, v56, v47, s57
    v_or3_b32 v95, v52, v53, v54
    v_or3_b32 v95, v95, v55, v56
    v_cmp_ne_u32 vcc, 0, v95
    s_add_u32 s7, s7, 1
    s_cbranch_vccz Lpolled_18
    v_cmp_ne_u32 s[32:33], 0, v52
    v_cmp_ne_u32 s[34:35], 0, v53
    v_cmp_ne_u32 s[36:37], 0, v54
    v_cmp_ne_u32 s[38:39], 0, v55
    v_cmp_ne_u32 s[40:41], 0, v56
    s_cmp_gt_u32 s7, 0x100000
    s_cbranch_scc0 Lpoll_17
Lpolled_18:
    v_perm_b32 v51, v49, v48, s61
    v_perm_b32 v51, v50, v51, s62
    v_mov_b32 v9, v51
    v_perm_b32 v35, v33, v32, s61
    v_perm_b32 v35, v34, v35, s62
    v_max_f32_dpp v9, v9, v9 quad_perm:[1,0,3,2] row_mask:0xf bank_mask:0xf
    v_perm_b32 v39, v37, v36, s61
    v_perm_b32 v39, v38, v39, s62
    v_max_f32_dpp v9, v9, v9 quad_perm:[2,3,0,1] row_mask:0xf bank_mask:0xf
    v_perm_b32 v43, v41, v40, s61
    v_perm_b32 v43, v42, v43, s62
    v_max_f32_dpp v9, v9, v9 row_half_mirror row_mask:0xf bank_mask:0xf
    v_perm_b32 v47, v45, v44, s61
    v_perm_b32 v47, v46, v47, s62
    v_max_f32_dpp v9, v9, v9 row_mirror row_mask:0xf bank_mask:0xf
    s_nop 0
    v_mov_b32 v10, v9
    s_nop 1
    v_permlane16_swap_b32 v9, v10
    s_nop 1
    v_max_f32 v9, v9, v10
    v_sub_f32 v10, v51, v9
    v_mul_f32 v10, s63, v10
    v_exp_f32 v10, v10
    s_nop 0
    v_mul_f32 v11, v10, v48
    v_readlane_b32 s74, v10, s70
    v_readlane_b32 s75, v10, s71
    v_readlane_b32 s76, v10, s73
    v_readlane_b32 s77, v10, s78
    v_add_f32_dpp v11, v11, v11 quad_perm:[1,0,3,2] row_mask:0xf bank_mask:0xf
    v_pk_mul_f32 v[12:13], s[74:75], v[32:33] op_sel_hi:[0,1]
    v_pk_mul_f32 v[14:15], s[74:75], v[34:35] op_sel_hi:[0,1]
    v_pk_fma_f32 v[12:13], s[74:75], v[36:37], v[12:13] op_sel:[1,0,0] op_sel_hi:[1,1,1]
    v_pk_fma_f32 v[14:15], s[74:75], v[38:39], v[14:15] op_sel:[1,0,0] op_sel_hi:[1,1,1]
    v_pk_fma_f32 v[12:13], s[76:77], v[40:41], v[12:13] op_sel:[0,0,0] op_sel_hi:[0,1,1]
    v_pk_fma_f32 v[14:15], s[76:77], v[42:43], v[14:15] op_sel:[0,0,0] op_sel_hi:[0,1,1]
    v_pk_fma_f32 v[12:13], s[76:77], v[44:45], v[12:13] op_sel:[1,0,0] op_sel_hi:[1,1,1]
    v_pk_fma_f32 v[14:15], s[76:77], v[46:47], v[14:15] op_sel:[1,0,0] op_sel_hi:[1,1,1]
    ds_write_b128 v72, v[12:15]
    v_add_f32_dpp v11, v11, v11 quad_perm:[2,3,0,1] row_mask:0xf bank_mask:0xf
    s_waitcnt lgkmcnt(0)
    s_barrier
    s_cmp_gt_u32 s3, 6
    s_cbranch_scc1 L_end
    ds_read_b128 v[32:35], v73 offset:0
    ds_read_b128 v[36:39], v73 offset:1024
    ds_read_b128 v[40:43], v73 offset:2048
    ds_read_b128 v[44:47], v73 offset:3072
    ds_read_b128 v[48:51], v73 offset:4096
    ds_read_b128 v[52:55], v73 offset:5120
    ds_read_b128 v[56:59], v73 offset:6144
    ds_read_b128 v[60:63], v73 offset:7168
    v_add_f32_dpp v11, v11, v11 row_half_mirror row_mask:0xf bank_mask:0xf
    s_nop 1
    v_add_f32_dpp v11, v11, v11 row_mirror row_mask:0xf bank_mask:0xf
    s_nop 0
    v_mov_b32 v10, v11
    s_nop 1
    v_permlane16_swap_b32 v11, v10
    s_nop 1
    v_add_f32 v11, v11, v10
    v_rcp_f32 v10, v11
    s_waitcnt lgkmcnt(6)
    v_pk_add_f32 v[32:33], v[32:33], v[36:37]
    v_pk_add_f32 v[34:35], v[34:35], v[38:39]
    s_waitcnt lgkmcnt(4)
    v_pk_add_f32 v[40:41], v[40:41], v[44:45]
    v_pk_add_f32 v[42:43], v[42:43], v[46:47]
    s_waitcnt lgkmcnt(2)
    v_pk_add_f32 v[48:49], v[48:49], v[52:53]
    v_pk_add_f32 v[50:51], v[50:51], v[54:55]
    s_waitcnt lgkmcnt(0)
    v_pk_add_f32 v[56:57], v[56:57], v[60:61]
    v_pk_add_f32 v[58:59], v[58:59], v[62:63]
    v_pk_add_f32 v[32:33], v[32:33], v[40:41]
    v_pk_add_f32 v[48:49], v[48:49], v[56:57]
    v_pk_add_f32 v[34:35], v[34:35], v[42:43]
    v_pk_add_f32 v[50:51], v[50:51], v[58:59]
    v_fma_f32 v9, -v10, v11, 1.0
    v_fma_f32 v10, v9, v10, v10
    v_pk_add_f32 v[32:33], v[32:33], v[48:49]
    v_pk_add_f32 v[34:35], v[34:35], v[50:51]
    v_pk_mul_f32 v[32:33], v[10:11], v[32:33] op_sel_hi:[0,1]
    v_pk_mul_f32 v[34:35], v[10:11], v[34:35] op_sel_hi:[0,1]
    v_cvt_pk_bf16_f32 v12, v32, v33
    v_cvt_pk_bf16_f32 v13, v34, v35
    s_nop 1
    v_mov_b32_dpp v40, v12 row_newbcast:0 row_mask:0xf bank_mask:0xf
    v_mov_b32_dpp v41, v13 row_newbcast:0 row_mask:0xf bank_mask:0xf
    v_mov_b32_dpp v42, v12 row_newbcast:1 row_mask:0xf bank_mask:0xf
    v_mov_b32_dpp v43, v13 row_newbcast:1 row_mask:0xf bank_mask:0xf
    v_mov_b32_dpp v44, v12 row_newbcast:2 row_mask:0xf bank_mask:0xf
    v_mov_b32_dpp v45, v13 row_newbcast:2 row_mask:0xf bank_mask:0xf
    v_mov_b32_dpp v46, v12 row_newbcast:3 row_mask:0xf bank_mask:0xf
    v_mov_b32_dpp v47, v13 row_newbcast:3 row_mask:0xf bank_mask:0xf
    v_mfma_f32_16x16x32_bf16 v[16:19], v[40:43], a[0:3], 0
    v_mov_b32_dpp v40, v12 row_newbcast:4 row_mask:0xf bank_mask:0xf
    v_mov_b32_dpp v41, v13 row_newbcast:4 row_mask:0xf bank_mask:0xf
    v_mov_b32_dpp v42, v12 row_newbcast:5 row_mask:0xf bank_mask:0xf
    v_mov_b32_dpp v43, v13 row_newbcast:5 row_mask:0xf bank_mask:0xf
    v_mfma_f32_16x16x32_bf16 v[16:19], v[44:47], a[4:7], v[16:19]
    v_mov_b32_dpp v44, v12 row_newbcast:6 row_mask:0xf bank_mask:0xf
    v_mov_b32_dpp v45, v13 row_newbcast:6 row_mask:0xf bank_mask:0xf
    v_mov_b32_dpp v46, v12 row_newbcast:7 row_mask:0xf bank_mask:0xf
    v_mov_b32_dpp v47, v13 row_newbcast:7 row_mask:0xf bank_mask:0xf
    v_mfma_f32_16x16x32_bf16 v[16:19], v[40:43], a[8:11], v[16:19]
    v_mov_b32_dpp v40, v12 row_newbcast:8 row_mask:0xf bank_mask:0xf
    v_mov_b32_dpp v41, v13 row_newbcast:8 row_mask:0xf bank_mask:0xf
    v_mov_b32_dpp v42, v12 row_newbcast:9 row_mask:0xf bank_mask:0xf
    v_mov_b32_dpp v43, v13 row_newbcast:9 row_mask:0xf bank_mask:0xf
    v_mfma_f32_16x16x32_bf16 v[16:19], v[44:47], a[12:15], v[16:19]
    v_mov_b32_dpp v44, v12 row_newbcast:10 row_mask:0xf bank_mask:0xf
    v_mov_b32_dpp v45, v13 row_newbcast:10 row_mask:0xf bank_mask:0xf
    v_mov_b32_dpp v46, v12 row_newbcast:11 row_mask:0xf bank_mask:0xf
    v_mov_b32_dpp v47, v13 row_newbcast:11 row_mask:0xf bank_mask:0xf
    v_mfma_f32_16x16x32_bf16 v[16:19], v[40:43], a[16:19], v[16:19]
    v_mov_b32_dpp v40, v12 row_newbcast:12 row_mask:0xf bank_mask:0xf
    v_mov_b32_dpp v41, v13 row_newbcast:12 row_mask:0xf bank_mask:0xf
    v_mov_b32_dpp v42, v12 row_newbcast:13 row_mask:0xf bank_mask:0xf
    v_mov_b32_dpp v43, v13 row_newbcast:13 row_mask:0xf bank_mask:0xf
    v_mfma_f32_16x16x32_bf16 v[16:19], v[44:47], a[20:23], v[16:19]
    v_mov_b32_dpp v44, v12 row_newbcast:14 row_mask:0xf bank_mask:0xf
    v_mov_b32_dpp v45, v13 row_newbcast:14 row_mask:0xf bank_mask:0xf
    v_mov_b32_dpp v46, v12 row_newbcast:15 row_mask:0xf bank_mask:0xf
    v_mov_b32_dpp v47, v13 row_newbcast:15 row_mask:0xf bank_mask:0xf
    v_mfma_f32_16x16x32_bf16 v[16:19], v[40:43], a[24:27], v[16:19]
    s_nop 0
    v_mfma_f32_16x16x32_bf16 v[16:19], v[44:47], a[28:31], v[16:19]
    s_nop 7
    v_mov_b32_dpp v25, v16 quad_perm:[3,3,3,3] row_mask:0xf bank_mask:0xf
    v_perm_b32 v24, v16, v25, v78
    s_nop 1
    v_add_u32_dpp v25, v24, v24 quad_perm:[1,0,3,2] row_mask:0xf bank_mask:0xf
    s_nop 1
    v_add_u32_dpp v25, v25, v25 quad_perm:[2,3,0,1] row_mask:0xf bank_mask:0xf
    v_sub_u32 v25, v79, v25
    v_cndmask_b32 v24, v24, v25, s[66:67]
    s_mov_b64 exec, 0xffff
    buffer_store_dword v24, v77, s[16:19], 0 offen sc1
    s_mov_b64 exec, -1
    s_branch L_end
L_s3:
    s_mov_b32 s24, s32
    s_mov_b32 s25, s33
    s_mov_b32 s26, 0x380
    s_mov_b32 s27, 0x20000
    v_and_b32 v9, 15, v0
    v_lshrrev_b32 v4, 4, v0
    v_lshl_add_u32 v5, v9, 2, v4
    s_lshl_b32 s30, s3, 6
    v_add_lshl_u32 v5, v5, s30, 1
    buffer_load_ushort v80, v5, s[24:27], 0 offen
    v_add_u32 v86, 103552, v5
    v_mul_u32_u24 v8, 8192, v4
    v_lshl_add_u32 v8, v9, 4, v8
    s_lshl_b32 s30, s3, 8
    s_add_u32 s30, s30, 1048576
    v_add_u32 v8, s30, v8
    v_add_u32 v10, 4096, v8
    v_bfe_u32 v3, v0, 2, 2
    v_lshl_add_u32 v3, v4, 3, v3
    v_lshlrev_b32 v6, 6, v3
    v_and_b32 v11, 3, v0
    v_lshl_add_u32 v6, v11, 3, v6
    s_and_b32 s30, s3, 1
    s_mul_i32 s30, s30, 28672
    s_bfe_u32 s31, s3, 0x10001
    s_lshl_b32 s31, s31, 5
    s_add_u32 s30, s30, s31
    s_lshr_b32 s31, s3, 2
    s_mul_i32 s31, s31, 14336
    s_add_u32 s30, s30, s31
    s_add_u32 s30, s30, 0
    v_add_u32 v6, s30, v6
    v_mul_u32_u24 v7, 0x380, v3
    v_lshl_add_u32 v7, v11, 3, v7
    s_lshl_b32 s30, s3, 7
    s_add_u32 s30, s30, 57344
    v_add_u32 v7, s30, v7
    s_lshr_b32 s30, s3, 2
    s_lshl_b32 s30, s30, 8
    s_and_b32 s31, s3, 1
    s_lshl_b32 s31, s31, 7
    s_add_u32 s30, s30, s31
    s_bfe_u32 s31, s3, 0x10001
    s_lshl_b32 s31, s31, 6
    s_add_u32 s30, s30, s31
    s_add_u32 s30, s30, 105600
    v_lshl_add_u32 v88, v9, 2, s30
    s_lshr_b32 s30, s3, 2
    s_mul_i32 s30, s30, 448
    s_add_u32 s30, s30, 103552
    v_lshl_add_u32 v89, v4, 4, s30
    v_and_b32 v11, 7, v0
    v_lshl_add_u32 v90, v4, 3, v11
    v_lshlrev_b32 v90, 2, v90
    v_add_u32 v90, 105600, v90
    v_and_b32 v11, 1, v0
    v_mov_b32 v91, 0x01000504
    v_mov_b32 v92, 0x05040100
    v_cmp_eq_u32 vcc, 1, v11
    s_mul_i32 s30, s69, 2048
    s_lshl_b32 s31, s3, 8
    v_cndmask_b32 v91, v91, v92, vcc
    s_add_u32 s30, s30, s31
    s_add_u32 s30, s30, 1179648
    v_lshl_add_u32 v93, v0, 2, s30
    s_mov_b32 s46, 0x88888888
    s_mov_b32 s47, 0x88888888
    v_and_b32 v60, 3, v0
    v_add_u32 v60, 0x07060501, v60
    v_mov_b32 v61, 0x0c0c0c0c
    v_cndmask_b32 v60, v60, v61, s[46:47]
    v_mov_b32 v61, s6
    s_lshl_b32 s30, s3, 3
    s_add_u32 s30, s30, 106624
    v_lshl_add_u32 v63, v4, 2, s30
    v_mov_b32 v40, 0
    s_mov_b32 s48, 0x00010001
    s_mov_b32 s49, 0
    s_mov_b64 exec, s[48:49]
    ds_write_b32 v63, v40
    s_mov_b64 exec, -1
    v_lshrrev_b32 v62, 3, v0
    v_mul_u32_u24 v62, 2048, v62
    v_and_b32 v12, 7, v0
    v_lshl_add_u32 v62, v12, 4, v62
    s_lshr_b32 s30, s69, 2
    s_lshl_b32 s30, s30, 7
    s_add_u32 s30, s30, 1179648
    v_add_u32 v62, s30, v62
    s_mov_b32 s40, 0xffff0000
    s_mov_b32 s41, 0
    s_mov_b32 s42, 0
    s_mov_b32 s43, 0x0000ffff
    s_mov_b32 s44, 0
    s_mov_b32 s45, 0xffff0000
    v_mov_b32 v81, 0x3d372713
    s_waitcnt vmcnt(0)
    s_barrier
    ds_read_b64_tr_b16 a[0:1], v6 offset:0
    ds_read_b64_tr_b16 a[2:3], v6 offset:256
    ds_read_b64_tr_b16 a[4:5], v6 offset:2048
    ds_read_b64_tr_b16 a[6:7], v6 offset:2304
    ds_read_b64_tr_b16 a[8:9], v6 offset:4096
    ds_read_b64_tr_b16 a[10:11], v6 offset:4352
    ds_read_b64_tr_b16 a[12:13], v6 offset:6144
    ds_read_b64_tr_b16 a[14:15], v6 offset:6400
    ds_read_b64_tr_b16 a[16:17], v6 offset:8192
    ds_read_b64_tr_b16 a[18:19], v6 offset:8448
    ds_read_b64_tr_b16 a[20:21], v6 offset:10240
    ds_read_b64_tr_b16 a[22:23], v6 offset:10496
    ds_read_b64_tr_b16 a[24:25], v6 offset:12288
    ds_read_b64_tr_b16 a[26:27], v6 offset:12544
    s_cmp_gt_u32 s3, 6
    s_cbranch_scc1 L_s3_notr
    ds_read_b64_tr_b16 a[32:33], v7 offset:0
    ds_read_b64_tr_b16 a[34:35], v7 offset:3584
    ds_read_b64_tr_b16 a[36:37], v7 offset:32
    ds_read_b64_tr_b16 a[38:39], v7 offset:3616
    ds_read_b64_tr_b16 a[40:41], v7 offset:64
    ds_read_b64_tr_b16 a[42:43], v7 offset:3648
    ds_read_b64_tr_b16 a[44:45], v7 offset:96
    ds_read_b64_tr_b16 a[46:47], v7 offset:3680
L_s3_notr:
    v_mov_b32 v20, 0x3f803f80
    v_mov_b32 v21, 0x3f803f80
    v_mov_b32 v22, 0x3f803f80
    v_mov_b32 v23, 0x3f803f80
    v_lshlrev_b32 v80, 16, v80
    s_waitcnt lgkmcnt(0)
    v_mfma_f32_16x16x32_bf16 v[16:19], v[20:23], a[0:3], 0
    v_mfma_f32_16x16x32_bf16 v[16:19], v[20:23], a[4:7], v[16:19]
    v_mfma_f32_16x16x32_bf16 v[16:19], v[20:23], a[8:11], v[16:19]
    v_mfma_f32_16x16x32_bf16 v[16:19], v[20:23], a[12:15], v[16:19]
    v_mfma_f32_16x16x32_bf16 v[16:19], v[20:23], a[16:19], v[16:19]
    v_mfma_f32_16x16x32_bf16 v[16:19], v[20:23], a[20:23], v[16:19]
    v_mfma_f32_16x16x32_bf16 v[16:19], v[20:23], a[24:27], v[16:19]
    s_nop 7
    s_mov_b64 exec, 0xffff
    ds_write_b32 v88, v16 offset:512
    s_mov_b64 exec, -1
    s_waitcnt lgkmcnt(0)
    s_barrier
    ds_read_b32 v16, v90 offset:512
    ds_read_b32 v17, v90 offset:768
    ds_read_b32 v18, v90 offset:640
    ds_read_b32 v19, v90 offset:896
    s_waitcnt lgkmcnt(0)
    v_add_f32 v94, v16, v17
    v_add_f32 v84, v18, v19
    s_cmp_gt_u32 s3, 6
    s_cbranch_scc1 L_s3_nogather
    s_mov_b32 s7, 0
    buffer_load_dwordx4 v[32:35], v8, s[16:19], 0 offen offset:0 sc1
    buffer_load_dwordx4 v[36:39], v8, s[16:19], 0 offen offset:2048 sc1
    buffer_load_dwordx4 v[40:43], v10, s[16:19], 0 offen offset:0 sc1
    buffer_load_dwordx4 v[44:47], v10, s[16:19], 0 offen offset:2048 sc1
    s_branch Lpoll_24w
Lpoll_24:
    s_cmp_eq_u64 s[32:33], 0
    s_cbranch_scc1 Lsk_26
    s_mov_b64 exec, s[32:33]
    buffer_load_dwordx4 v[32:35], v8, s[16:19], 0 offen offset:0 sc1
Lsk_26:
    s_cmp_eq_u64 s[34:35], 0
    s_cbranch_scc1 Lsk_27
    s_mov_b64 exec, s[34:35]
    buffer_load_dwordx4 v[36:39], v8, s[16:19], 0 offen offset:2048 sc1
Lsk_27:
    s_cmp_eq_u64 s[36:37], 0
    s_cbranch_scc1 Lsk_28
    s_mov_b64 exec, s[36:37]
    buffer_load_dwordx4 v[40:43], v10, s[16:19], 0 offen offset:0 sc1
Lsk_28:
    s_cmp_eq_u64 s[38:39], 0
    s_cbranch_scc1 Lsk_29
    s_mov_b64 exec, s[38:39]
    buffer_load_dwordx4 v[44:47], v10, s[16:19], 0 offen offset:2048 sc1
Lsk_29:
    s_mov_b64 exec, -1
Lpoll_24w:
    s_waitcnt vmcnt(0)
    v_add3_u32 v48, v32, v33, v34
    v_add3_u32 v49, v36, v37, v38
    v_add3_u32 v50, v40, v41, v42
    v_add3_u32 v51, v44, v45, v46
    v_add3_u32 v48, v48, v35, s57
    v_add3_u32 v49, v49, v39, s57
    v_add3_u32 v50, v50, v43, s57
    v_add3_u32 v51, v51, v47, s57
    v_or3_b32 v12, v48, v49, v50
    v_or_b32 v12, v12, v51
    v_cmp_ne_u32 vcc, 0, v12
    s_add_u32 s7, s7, 1
    s_cbranch_vccz Lpolled_25
    v_cmp_ne_u32 s[32:33], 0, v48
    v_cmp_ne_u32 s[34:35], 0, v49
    v_cmp_ne_u32 s[36:37], 0, v50
    v_cmp_ne_u32 s[38:39], 0, v51
    s_cmp_gt_u32 s7, 0x100000
    s_cbranch_scc0 Lpoll_24
Lpolled_25:
    v_perm_b32 v35, v33, v32, s61
    v_perm_b32 v35, v34, v35, s62
    v_perm_b32 v39, v37, v36, s61
    v_perm_b32 v39, v38, v39, s62
    v_perm_b32 v43, v41, v40, s61
    v_perm_b32 v43, v42, v43, s62
    v_perm_b32 v47, v45, v44, s61
    v_perm_b32 v47, v46, v47, s62
    v_pk_add_f32 v[32:33], v[32:33], v[36:37]
    v_pk_add_f32 v[40:41], v[40:41], v[44:45]
    v_pk_add_f32 v[34:35], v[34:35], v[38:39]
    v_pk_add_f32 v[42:43], v[42:43], v[46:47]
    v_pk_add_f32 v[32:33], v[32:33], v[40:41]
    v_pk_add_f32 v[34:35], v[34:35], v[42:43]
    s_nop 1
    v_permlane16_swap_b32 v32, v33
    v_permlane16_swap_b32 v34, v35
    s_nop 0
    v_add_f32 v32, v32, v33
    v_add_f32 v34, v34, v35
    s_nop 1
    v_permlane32_swap_b32 v32, v34
    s_nop 0
    v_add_f32 v32, v32, v34
    v_cvt_pk_bf16_f32 v32, v32, v32
    v_lshlrev_b32 v32, 16, v32
    v_add_f32 v32, v32, v80
    v_cvt_pk_bf16_f32 v36, v32, v32
    ds_write_b16 v86, v36
    v_lshlrev_b32 v40, 16, v36
    v_mul_f32 v41, v40, v40
    s_nop 0
    v_add_f32_dpp v40, v40, v40 quad_perm:[1,0,3,2] row_mask:0xf bank_mask:0xf
    v_add_f32_dpp v41, v41, v41 quad_perm:[1,0,3,2] row_mask:0xf bank_mask:0xf
    s_nop 0
    v_add_f32_dpp v40, v40, v40 quad_perm:[2,3,0,1] row_mask:0xf bank_mask:0xf
    v_add_f32_dpp v41, v41, v41 quad_perm:[2,3,0,1] row_mask:0xf bank_mask:0xf
    s_nop 0
    v_add_f32_dpp v40, v40, v40 row_half_mirror row_mask:0xf bank_mask:0xf
    v_add_f32_dpp v41, v41, v41 row_half_mirror row_mask:0xf bank_mask:0xf
    s_nop 0
    v_add_f32_dpp v40, v40, v40 row_mirror row_mask:0xf bank_mask:0xf
    v_add_f32_dpp v41, v41, v41 row_mirror row_mask:0xf bank_mask:0xf
    s_nop 0
    s_nop 0
    v_permlane16_swap_b32 v40, v41
    s_nop 0
    v_add_f32 v40, v40, v41
    v_mov_b32 v41, v40
    s_nop 1
    v_permlane32_swap_b32 v40, v41
    s_nop 0
    v_add_f32 v40, v40, v41
    s_mov_b64 exec, s[48:49]
    ds_write_b32 v63, v40
    s_mov_b64 exec, -1
L_s3_nogather:
    s_waitcnt lgkmcnt(0)
    s_barrier
    ds_read_b128 v[64:67], v89 offset:0
    ds_read_b128 v[68:71], v89 offset:64
    ds_read_b128 v[72:75], v89 offset:128
    ds_read_b128 v[76:79], v89 offset:192
    ds_read_b128 v[48:51], v89 offset:256
    ds_read_b128 v[52:55], v89 offset:320
    ds_read_b128 v[56:59], v89 offset:384
    v_mov_b32 v8, 106624
    ds_read_b128 v[24:27], v8 offset:0
    ds_read_b128 v[28:31], v8 offset:16
    ds_read_b128 v[32:35], v8 offset:32
    ds_read_b128 v[36:39], v8 offset:48
    s_waitcnt lgkmcnt(10)
    v_mfma_f32_16x16x32_bf16 v[16:19], v[64:67], a[0:3], 0
    s_waitcnt lgkmcnt(9)
    v_mfma_f32_16x16x32_bf16 v[16:19], v[68:71], a[4:7], v[16:19]
    s_waitcnt lgkmcnt(8)
    v_mfma_f32_16x16x32_bf16 v[16:19], v[72:75], a[8:11], v[16:19]
    s_waitcnt lgkmcnt(7)
    v_mfma_f32_16x16x32_bf16 v[16:19], v[76:79], a[12:15], v[16:19]
    s_waitcnt lgkmcnt(6)
    v_mfma_f32_16x16x32_bf16 v[16:19], v[48:51], a[16:19], v[16:19]
    s_waitcnt lgkmcnt(5)
    v_mfma_f32_16x16x32_bf16 v[16:19], v[52:55], a[20:23], v[16:19]
    s_waitcnt lgkmcnt(4)
    v_mfma_f32_16x16x32_bf16 v[16:19], v[56:59], a[24:27], v[16:19]
    s_waitcnt lgkmcnt(0)
    v_pk_add_f32 v[24:25], v[24:25], v[26:27]
    v_pk_add_f32 v[28:29], v[28:29], v[30:31]
    v_pk_add_f32 v[32:33], v[32:33], v[34:35]
    v_pk_add_f32 v[36:37], v[36:37], v[38:39]
    v_pk_add_f32 v[24:25], v[24:25], v[28:29]
    v_pk_add_f32 v[32:33], v[32:33], v[36:37]
    v_pk_add_f32 v[24:25], v[24:25], v[32:33]
    v_mul_f32 v44, 0x3b124925, v24
    v_mul_f32 v42, 0x3b124925, v25
    s_mov_b64 exec, 0xffff
    ds_write_b32 v88, v16
    s_mov_b64 exec, -1
    v_fma_f32 v42, -v44, v44, v42
    v_max_f32 v42, 0, v42
    v_cvt_pk_bf16_f32 v40, v44, v42
    v_and_b32 v42, 0xffff0000, v40
    v_lshlrev_b32 v40, 16, v40
    v_add_f32 v42, 0x3727c5ac, v42
    v_cvt_pk_bf16_f32 v42, v42, v42
    v_lshlrev_b32 v42, 16, v42
    v_sqrt_f32 v41, v42
    s_nop 0
    v_cvt_pk_bf16_f32 v41, v41, v41
    v_lshlrev_b32 v41, 16, v41
    v_rcp_f32 v42, v41
    s_waitcnt lgkmcnt(0)
    s_barrier
    s_cmp_gt_u32 s3, 6
    s_cbranch_scc1 L_s3_w7
    ds_read_b32 v16, v90
    ds_read_b32 v17, v90 offset:256
    ds_read_b32 v18, v90 offset:128
    ds_read_b32 v19, v90 offset:384
    s_waitcnt lgkmcnt(2)
    v_add_f32 v16, v16, v17
    v_fma_f32 v16, -v40, v94, v16
    s_waitcnt lgkmcnt(0)
    v_add_f32 v18, v18, v19
    v_fma_f32 v18, -v40, v84, v18
    v_mul_f32 v16, v16, v42
    v_mul_f32 v18, v18, v42
    v_cvt_pk_bf16_f32 v17, v16, v18
    v_lshlrev_b32 v16, 16, v17
    v_and_b32 v18, 0xffff0000, v17
    v_mul_f32 v17, v16, v16
    v_mul_f32 v17, v17, v16
    v_fma_f32 v17, v17, v81, v16
    v_mul_f32 v17, 0xc0135761, v17
    v_min_f32 v17, 0x42fc0000, v17
    v_exp_f32 v17, v17
    s_nop 0
    v_add_f32 v17, 1.0, v17
    v_rcp_f32 v19, v17
    s_nop 0
    v_mul_f32 v20, v16, v19
    v_cvt_pk_bf16_f32 v20, v20, v20
    v_lshlrev_b32 v20, 16, v20
    v_mul_f32 v20, v20, v18
    v_cvt_pk_bf16_f32 v20, v20, v20
    s_nop 1
    v_mov_b32_dpp v21, v20 quad_perm:[1,0,3,2] row_mask:0xf bank_mask:0xf
    v_perm_b32 v20, v20, v21, v91
    s_nop 1
    v_mov_b32_dpp v16, v20 row_newbcast:0 row_mask:0xf bank_mask:0xf
    v_mov_b32_dpp v17, v20 row_newbcast:2 row_mask:0xf bank_mask:0xf
    v_mov_b32_dpp v18, v20 row_newbcast:4 row_mask:0xf bank_mask:0xf
    v_mov_b32_dpp v19, v20 row_newbcast:6 row_mask:0xf bank_mask:0xf
    s_nop 1
    v_mfma_f32_16x16x32_bf16 v[32:35], v[16:19], a[32:35], 0
    v_mfma_f32_16x16x32_bf16 v[36:39], v[16:19], a[36:39], 0
    v_mfma_f32_16x16x32_bf16 v[40:43], v[16:19], a[40:43], 0
    v_mfma_f32_16x16x32_bf16 v[44:47], v[16:19], a[44:47], 0
    s_nop 5
    v_cndmask_b32 v32, v32, v36, s[40:41]
    v_cndmask_b32 v32, v32, v40, s[42:43]
    s_nop 0
    v_cndmask_b32 v32, v32, v44, s[44:45]
    s_nop 1
    v_mov_b32_dpp v25, v32 quad_perm:[3,3,3,3] row_mask:0xf bank_mask:0xf
    v_perm_b32 v24, v32, v25, v60
    s_nop 1
    v_add_u32_dpp v25, v24, v24 quad_perm:[1,0,3,2] row_mask:0xf bank_mask:0xf
    s_nop 1
    v_add_u32_dpp v25, v25, v25 quad_perm:[2,3,0,1] row_mask:0xf bank_mask:0xf
    v_sub_u32 v25, v61, v25
    v_cndmask_b32 v24, v24, v25, s[46:47]
    buffer_store_dword v24, v93, s[16:19], 0 offen sc1
    s_waitcnt vmcnt(0)
    s_barrier
    s_branch L_end
L_s3_w7:
    s_and_b32 s30, s69, 3
    s_cmp_lg_u32 s30, 0
    s_cbranch_scc1 L_end
    v_and_b32 v12, 7, v0
    v_lshl_add_u32 v5, v12, 2, v4
    s_lshl_b32 s30, s69, 3
    v_add_lshl_u32 v5, v5, s30, 1
    v_add_u32 v8, 103552, v5
    ds_read_u16 v32, v8
    s_mov_b32 s24, s50
    s_mov_b32 s25, s51
    s_mov_b32 s26, 0x380
    s_mov_b32 s27, 0x20000
    v_add_u32 v16, 0, v62
    v_add_u32 v17, 16384, v62
    v_add_u32 v18, 32768, v62
    v_add_u32 v19, 49152, v62
    v_add_u32 v20, 65536, v62
    v_add_u32 v21, 81920, v62
    v_add_u32 v22, 98304, v62
    s_mov_b32 s48, 0x00ff00ff
    s_mov_b32 s49, 0x00ff00ff
    s_waitcnt lgkmcnt(0)
    v_lshlrev_b32 v32, 16, v32
    s_barrier
    s_mov_b32 s7, 0
    buffer_load_dwordx4 v[64:67], v16, s[16:19], 0 offen offset:0 sc1
    buffer_load_dwordx4 v[68:71], v17, s[16:19], 0 offen offset:0 sc1
    buffer_load_dwordx4 v[72:75], v18, s[16:19], 0 offen offset:0 sc1
    buffer_load_dwordx4 v[76:79], v19, s[16:19], 0 offen offset:0 sc1
    buffer_load_dwordx4 v[80:83], v20, s[16:19], 0 offen offset:0 sc1
    buffer_load_dwordx4 v[84:87], v21, s[16:19], 0 offen offset:0 sc1
    buffer_load_dwordx4 v[88:91], v22, s[16:19], 0 offen offset:0 sc1
    s_branch Lpoll_30w
Lpoll_30:
    s_cmp_eq_u64 s[32:33], 0
    s_cbranch_scc1 Lsk_32
    s_mov_b64 exec, s[32:33]
    buffer_load_dwordx4 v[64:67], v16, s[16:19], 0 offen offset:0 sc1
Lsk_32:
    s_cmp_eq_u64 s[34:35], 0
    s_cbranch_scc1 Lsk_33
    s_mov_b64 exec, s[34:35]
    buffer_load_dwordx4 v[68:71], v17, s[16:19], 0 offen offset:0 sc1
Lsk_33:
    s_cmp_eq_u64 s[36:37], 0
    s_cbranch_scc1 Lsk_34
    s_mov_b64 exec, s[36:37]
    buffer_load_dwordx4 v[72:75], v18, s[16:19], 0 offen offset:0 sc1
Lsk_34:
    s_cmp_eq_u64 s[38:39], 0
    s_cbranch_scc1 Lsk_35
    s_mov_b64 exec, s[38:39]
    buffer_load_dwordx4 v[76:79], v19, s[16:19], 0 offen offset:0 sc1
Lsk_35:
    s_cmp_eq_u64 s[40:41], 0
    s_cbranch_scc1 Lsk_36
    s_mov_b64 exec, s[40:41]
    buffer_load_dwordx4 v[80:83], v20, s[16:19], 0 offen offset:0 sc1
Lsk_36:
    s_cmp_eq_u64 s[42:43], 0
    s_cbranch_scc1 Lsk_37
    s_mov_b64 exec, s[42:43]
    buffer_load_dwordx4 v[84:87], v21, s[16:19], 0 offen offset:0 sc1
Lsk_37:
    s_cmp_eq_u64 s[44:45], 0
    s_cbranch_scc1 Lsk_38
    s_mov_b64 exec, s[44:45]
    buffer_load_dwordx4 v[88:91], v22, s[16:19], 0 offen offset:0 sc1
Lsk_38:
    s_mov_b64 exec, -1
Lpoll_30w:
    s_waitcnt vmcnt(0)
    v_add3_u32 v24, v64, v65, v66
    v_add3_u32 v25, v68, v69, v70
    v_add3_u32 v26, v72, v73, v74
    v_add3_u32 v27, v76, v77, v78
    v_add3_u32 v28, v80, v81, v82
    v_add3_u32 v29, v84, v85, v86
    v_add3_u32 v30, v88, v89, v90
    v_add3_u32 v24, v24, v67, s57
    v_add3_u32 v25, v25, v71, s57
    v_add3_u32 v26, v26, v75, s57
    v_add3_u32 v27, v27, v79, s57
    v_add3_u32 v28, v28, v83, s57
    v_add3_u32 v29, v29, v87, s57
    v_add3_u32 v30, v30, v91, s57
    v_or3_b32 v95, v24, v25, v26
    v_or3_b32 v95, v95, v27, v28
    v_or3_b32 v95, v95, v29, v30
    v_cmp_ne_u32 vcc, 0, v95
    s_add_u32 s7, s7, 1
    s_cbranch_vccz Lpolled_31
    v_cmp_ne_u32 s[32:33], 0, v24
    v_cmp_ne_u32 s[34:35], 0, v25
    v_cmp_ne_u32 s[36:37], 0, v26
    v_cmp_ne_u32 s[38:39], 0, v27
    v_cmp_ne_u32 s[40:41], 0, v28
    v_cmp_ne_u32 s[42:43], 0, v29
    v_cmp_ne_u32 s[44:45], 0, v30
    s_cmp_gt_u32 s7, 0x100000
    s_cbranch_scc0 Lpoll_30
Lpolled_31:
    v_perm_b32 v67, v65, v64, s61
    v_perm_b32 v67, v66, v67, s62
    v_perm_b32 v71, v69, v68, s61
    v_perm_b32 v71, v70, v71, s62
    v_perm_b32 v75, v73, v72, s61
    v_perm_b32 v75, v74, v75, s62
    v_perm_b32 v79, v77, v76, s61
    v_perm_b32 v79, v78, v79, s62
    v_perm_b32 v83, v81, v80, s61
    v_perm_b32 v83, v82, v83, s62
    v_perm_b32 v87, v85, v84, s61
    v_perm_b32 v87, v86, v87, s62
    v_perm_b32 v91, v89, v88, s61
    v_perm_b32 v91, v90, v91, s62
    v_pk_add_f32 v[64:65], v[64:65], v[68:69]
    v_pk_add_f32 v[72:73], v[72:73], v[76:77]
    v_pk_add_f32 v[80:81], v[80:81], v[84:85]
    v_pk_add_f32 v[66:67], v[66:67], v[70:71]
    v_pk_add_f32 v[74:75], v[74:75], v[78:79]
    v_pk_add_f32 v[82:83], v[82:83], v[86:87]
    v_pk_add_f32 v[64:65], v[64:65], v[72:73]
    v_pk_add_f32 v[80:81], v[80:81], v[88:89]
    v_pk_add_f32 v[66:67], v[66:67], v[74:75]
    v_pk_add_f32 v[82:83], v[82:83], v[90:91]
    v_pk_add_f32 v[64:65], v[64:65], v[80:81]
    v_pk_add_f32 v[66:67], v[66:67], v[82:83]
    s_nop 0
    v_add_f32_dpp v64, v64, v64 row_ror:8 row_mask:0xf bank_mask:0xf
    v_add_f32_dpp v65, v65, v65 row_ror:8 row_mask:0xf bank_mask:0xf
    v_add_f32_dpp v66, v66, v66 row_ror:8 row_mask:0xf bank_mask:0xf
    v_add_f32_dpp v67, v67, v67 row_ror:8 row_mask:0xf bank_mask:0xf
    s_nop 1
    v_permlane16_swap_b32 v64, v65
    v_permlane16_swap_b32 v66, v67
    s_nop 0
    v_add_f32 v64, v64, v65
    v_add_f32 v66, v66, v67
    s_nop 1
    v_permlane32_swap_b32 v64, v66
    s_nop 0
    v_add_f32 v64, v64, v66
    v_cvt_pk_bf16_f32 v64, v64, v64
    v_lshlrev_b32 v64, 16, v64
    v_add_f32 v64, v64, v32
    v_cvt_pk_bf16_f32 v68, v64, v64
    s_mov_b64 exec, s[48:49]
    buffer_store_short v68, v5, s[24:27], 0 offen sc1
    s_cmp_lg_u32 s69, 0
    s_cbranch_scc1 L_s4_done
    v_mov_b32 v8, s6
    v_mov_b32 v9, 0
    s_mov_b64 exec, 1
    buffer_store_dword v8, v9, s[16:19], 0 offen sc1
L_s4_done:
    s_mov_b64 exec, -1
L_end:
L_exit:
    s_endpgm
.section .rodata,"a"
.p2align 6
.amdhsa_kernel sequential_preLN__gqa_block_cached__geglu_ffn__decode_kernel
  .amdhsa_next_free_vgpr 224
  .amdhsa_next_free_sgpr 102
  .amdhsa_accum_offset 96
  .amdhsa_group_segment_fixed_size 0
  .amdhsa_kernarg_size 96
  .amdhsa_user_sgpr_count 2
  .amdhsa_user_sgpr_kernarg_segment_ptr 1
  .amdhsa_system_sgpr_workgroup_id_x 1
.end_amdhsa_kernel
```
